```python
import torch

def _softmax(x, axis=-1):
    return torch.softmax(x, dim=axis)
def _gelu(x):
    return torch.nn.functional.gelu(x, approximate="tanh")
def _silu(x):
    return torch.nn.functional.silu(x)
def _sigmoid(x):
    return torch.sigmoid(x)
def _layernorm(x, axis=-1, eps=1e-5):
    m = x.mean(dim=axis, keepdim=True)
    v = x.var(dim=axis, keepdim=True, unbiased=False)
    return (x - m) / torch.sqrt(v + eps)
def _scatter_add(tgt, idx, src, axis=0):
    return tgt.clone().index_add_(axis, idx, src)
def _segment_sum(src, seg, n):
    out = torch.zeros((n,) + src.shape[1:], dtype=src.dtype)
    return out.index_add_(0, seg, src)
def _pad(x, pw):
    flat = tuple(v for pair in reversed(pw) for v in pair)
    return torch.nn.functional.pad(x, flat)

kernel_name = 'standalone__sequential_behavior_din__recsys'

def setup_inputs():

    _w = (lambda a: (lambda t: t.to(torch.bfloat16) if t.is_floating_point() else t)(torch.as_tensor(a)))
    B, L, D = 16384, 50, 16
    H = D
    return {
        "target": _w((lambda *s: torch.randn(*s, dtype=torch.bfloat16) * 1.6)(B, D)),
        "hist": _w((lambda *s: torch.randn(*s, dtype=torch.bfloat16) * 1.6)(B, L, D)),
        "mask": _w((lambda lo, hi, *s: torch.randint(lo, hi, s))(0, 2, B, L).to(float)),
        "w1": _w((lambda *s: torch.randn(*s, dtype=torch.bfloat16) * 1.6)(4 * D, H) * (4 * D) ** -0.5),
        "b1": _w((lambda *s: torch.randn(*s, dtype=torch.bfloat16) * 1.6)(H) * 0.1),
        "w2": _w((lambda *s: torch.randn(*s, dtype=torch.bfloat16) * 0.05)(H, 1) * H ** -0.5),
        "b2": _w((lambda *s: torch.randn(*s, dtype=torch.bfloat16) * 0.05)(1) * 0.1),
    }

def reference(target, hist, mask, w1, b1, w2, b2):
    L = hist.shape[1]
    tgt = (lambda x, n, axis: torch.repeat_interleave(x, n, dim=axis))(target[:, None, :], L, axis=1)
    feat = torch.concatenate([hist, tgt, hist - tgt, hist * tgt], axis=-1)
    h = _sigmoid(feat @ w1 + b1)
    scores = (h @ w2 + b2)[..., 0] * mask
    return torch.einsum('bl,bld->bd', scores, hist)
```

```asm
; @launch grid=(1024,1,1) block=(256,1,1) lds=35200
.amdgcn_target "amdgcn-amd-amdhsa--gfx950"
.text
.globl standalone__sequential_behavior_din__recsys_kernel
.p2align 8
.type standalone__sequential_behavior_din__recsys_kernel,@function
standalone__sequential_behavior_din__recsys_kernel:
    s_cmp_ge_u32 s2, 1024
    s_cbranch_scc1 L_done
    s_load_dwordx16 s[4:19], s[0:1], 0
    s_getreg_b32 s52, hwreg(HW_REG_HW_ID, 0, 4)
    s_cmp_ge_u32 s52, 2
    s_cbranch_scc1 L_path2
    s_cmp_ge_u32 s52, 1
    s_cbranch_scc1 L_path1
    v_lshrrev_b32 v116, 6, v0
    v_and_b32 v110, 63, v0
    v_readfirstlane_b32 s3, v116
    s_getpc_b64 s[54:55]
L_pc:
    s_cmp_lg_u32 s3, 0
    s_cbranch_scc1 L_npf
    s_getreg_b32 s53, hwreg(HW_REG_HW_ID, 8, 1)
    s_lshl_b32 s53, s53, 13
    v_lshl_add_u32 v118, v110, 7, s53
    v_min_u32 v118, L_codeend-L_pc-4, v118
    global_load_dword v26, v118, s[54:55]
L_npf:
    v_add_u32 v113, v0, v0
    v_add_u32 v111, v110, v110
    v_add_u32 v112, v110, v110
    v_lshlrev_b32 v1, 4, v110
    v_and_b32 v114, 15, v110
    v_lshrrev_b32 v115, 4, v110
    v_mov_b32 v119, 0
    v_add_u32 v117, v114, v114
    s_mul_i32 s36, s3, 7936
    s_add_u32 s36, s36, 3456
    s_mul_i32 s32, s2, 4
    s_add_u32 s32, s32, s3
    s_mul_i32 s33, s32, 6400
    s_mul_i32 s34, s32, 400
    s_lshl_b32 s35, s32, 7
    s_add_u32 s41, s36, 6400
    s_mov_b32 s40, s41
    s_mov_b32 s37, 0xbfb8aa3b
    s_mov_b32 s22, 26214400
    s_mov_b32 s23, 0x20000
    s_mov_b32 s26, 1638400
    s_mov_b32 s27, 0x20000
    s_mov_b32 s30, 524288
    s_mov_b32 s31, 0x20000
    s_mov_b32 s46, 524288
    s_mov_b32 s47, 0x20000
    s_mov_b32 m0, s36
    s_mov_b32 s42, s3
    v_add_u32 v124, v1, v1
    s_mov_b32 exec_lo, 0
    s_mov_b32 exec_hi, 0xfffc0000
    v_mov_b32 v112, 0x7ff00000
    v_mov_b32 v124, 1568
    s_mov_b64 exec, -1
    s_waitcnt lgkmcnt(0)
    s_load_dwordx8 s[72:79], s[14:15], 0
    s_mov_b32 s20, s6
    s_and_b32 s21, s7, 0xffff
    s_add_u32 s38, s33, 4096
    s_cmp_lg_u32 s42, 0
    s_cbranch_scc1 L_nb0
    global_load_short_d16_hi v105, v119, s[16:17]
    global_load_short_d16_hi v102, v117, s[12:13]
    global_load_short_d16_hi v103, v117, s[14:15]
L_nb0:
    global_load_short_d16_hi v98, v113, s[10:11]
    global_load_short_d16_hi v99, v113, s[10:11] offset:512
    global_load_short_d16_hi v100, v113, s[10:11] offset:1024
    global_load_short_d16_hi v101, v113, s[10:11] offset:1536
    s_mov_b32 s44, s4
    s_and_b32 s45, s5, 0xffff
    buffer_load_short_d16_hi v104, v111, s[44:47], s35 offen
    s_mov_b32 s24, s8
    s_and_b32 s25, s9, 0xffff
    s_mov_b32 m0, s41
    s_mov_b32 exec_lo, 0x1ffffff
    s_mov_b32 exec_hi, 0
    buffer_load_dwordx4 v1, s[24:27], s34 offen lds
    s_mov_b64 exec, -1
    s_mov_b32 m0, s36
    v_mov_b32 v106, 0
    v_mov_b32 v107, 0
    v_mov_b32 v108, 0
    v_mov_b32 v109, 0
    buffer_load_dwordx4 v1, s[20:23], s33 offen lds
    buffer_load_dwordx4 v1, s[20:23], s33 offen offset:1024 lds
    buffer_load_dwordx4 v1, s[20:23], s33 offen offset:2048 lds
    buffer_load_dwordx4 v1, s[20:23], s33 offen offset:3072 lds
    s_mov_b32 s28, s18
    s_and_b32 s29, s19, 0xffff
    s_mov_b32 s39, 0xffff
    s_lshl_b32 s49, s3, 8
    s_mov_b32 s56, 0x3380
    s_mov_b32 s57, 0
    v_sub_u32 v125, 63, v110
    v_lshlrev_b32 v116, 3, v115
    v_lshl_add_u32 v17, v114, 5, v116
    v_add_u32 v121, v116, v116
    v_add_u32 v122, s36, v121
    v_add_u32 v15, s36, v111
    v_add_u32 v123, v15, v111
    s_add_u32 s50, s36, 7424
    v_and_b32 v119, 0x38, v17
    v_add_u32 v16, s50, v119
    v_add_u32 v2, s36, v116
    v_and_b32 v119, 3, v110
    v_lshl_add_u32 v4, v119, 3, s36
    v_lshl_add_u32 v5, v114, 3, s41
    v_and_b32 v119, 0x78, v111
    v_add_u32 v6, s41, v119
    v_lshrrev_b32 v119, 5, v110
    v_lshl_add_u32 v7, v119, 2, v5
    v_and_b32 v119, 16, v110
    v_lshl_add_u32 v7, v119, 4, v7
    v_lshl_add_u32 v119, v114, 4, s49
    v_lshl_add_u32 v120, v115, 2, v119
    v_lshlrev_b32 v118, 2, v114
    v_and_b32 v116, 2, v114
    v_lshlrev_b32 v116, 5, v116
    v_and_b32 v119, 12, v114
    v_lshl_add_u32 v116, v119, 2, v116
    v_and_b32 v119, 1, v114
    v_lshl_add_u32 v116, v119, 3, v116
    s_waitcnt lgkmcnt(0)
    s_and_b32 s4, s72, 0x7f807f80
    s_and_b32 s5, s73, 0x7f807f80
    s_and_b32 s6, s74, 0x7f807f80
    s_and_b32 s7, s75, 0x7f807f80
    s_and_b32 s8, s76, 0x7f807f80
    s_and_b32 s9, s77, 0x7f807f80
    s_and_b32 s10, s78, 0x7f807f80
    s_and_b32 s11, s79, 0x7f807f80
    s_lshl_b32 s12, s4, 16
    s_lshl_b32 s13, s5, 16
    s_lshl_b32 s14, s6, 16
    s_lshl_b32 s15, s7, 16
    s_lshl_b32 s16, s8, 16
    s_lshl_b32 s17, s9, 16
    s_lshl_b32 s18, s10, 16
    s_lshl_b32 s19, s11, 16
    s_max_u32 s4, s4, s12
    s_max_u32 s5, s5, s13
    s_max_u32 s6, s6, s14
    s_max_u32 s7, s7, s15
    s_max_u32 s8, s8, s16
    s_max_u32 s9, s9, s17
    s_max_u32 s10, s10, s18
    s_max_u32 s11, s11, s19
    s_max_u32 s4, s4, s8
    s_max_u32 s5, s5, s9
    s_max_u32 s6, s6, s10
    s_max_u32 s7, s7, s11
    s_max_u32 s4, s4, s6
    s_max_u32 s5, s5, s7
    s_max_u32 s4, s4, s5
    s_and_b32 s4, s4, 0x7f800000
    s_max_u32 s4, s4, 0xc800000
    s_min_u32 s4, s4, 0x7e800000
    s_sub_u32 s5, 0x7f000000, s4
    s_lshr_b32 s56, s4, 16
    s_sub_u32 s56, s56, 0xc00
    s_mov_b32 s6, 0x7fffffff
    s_mov_b32 s7, 0x31800000
    s_mov_b32 s8, 0xc1c00000
    v_lshlrev_b64 v[12:13], v123, s[56:57]
    s_waitcnt vmcnt(7)
    v_add_f32 v98, v98, v100
    v_sub_f32 v99, v99, v100
    v_mul_f32 v98, s37, v98
    v_mul_f32 v99, s37, v99
    s_waitcnt vmcnt(6)
    v_mul_f32 v101, s37, v101
    ds_write_b32 v120, v98
    v_cvt_pk_bf16_f32 v117, v99, v99
    ds_write_b32 v120, v101 offset:1024
    ds_write_b32 v120, v117 offset:2048
    s_cmp_lg_u32 s42, 0
    s_cbranch_scc1 L_np0
    v_mul_f32 v103, s5, v103
    v_mul_f32 v102, s37, v102
    v_max_f32_e64 v82, |v103|, s7
    v_bfi_b32 v82, s6, v82, v103
    v_rcp_f32 v86, v82
    v_add_f32 v102, s8, v102
    v_mul_f32 v87, 0x33800000, v86
    s_mov_b64 exec, 0xffff
    ds_write_b32 v118, v102 offset:3072
    ds_write_b64 v116, v[86:87] offset:3136
    ds_write_b32 v118, v105 offset:3264
    s_mov_b64 exec, -1
L_np0:
    s_waitcnt vmcnt(5)
    ds_write_b32 v123, v104 offset:7680
    s_waitcnt vmcnt(4)
    s_mov_b32 exec_hi, 0x3ffff
    ds_read_u16_d16_hi v106, v15 offset:6400
    ds_read_u16_d16_hi v107, v15 offset:6500
    ds_read_u16_d16_hi v108, v15 offset:6600
    ds_read_u16_d16_hi v109, v15 offset:6700
    s_mov_b32 exec_hi, -1
    s_waitcnt lgkmcnt(0)
    s_barrier
    ds_read_b128 v[66:69], v122 offset:7680
    ds_read_b128 v[70:73], v122 offset:7744
    ds_read_b128 v[50:53], v1
    ds_read_b128 v[54:57], v1 offset:1024
    ds_read_b128 v[74:77], v122 offset:7808
    ds_read_b128 v[78:81], v122 offset:7872
    ds_read_b128 v[58:61], v1 offset:2048
    ds_read_b128 v[62:65], v121 offset:3072
    ds_read_b128 v[8:11], v121 offset:3136
    ds_read_b32 v14, v121 offset:3264
    v_cmp_lt_u32 s[48:49], s39, v106
    v_cmp_lt_u32 s[50:51], s39, v107
    v_cmp_lt_u32 s[52:53], s39, v108
    v_cmp_lt_u32 s[54:55], s39, v109
    v_or_b32 v106, v124, v106
    v_or_b32 v107, v124, v107
    v_or_b32 v108, v124, v108
    v_or_b32 v109, v124, v109
    v_cndmask_b32 v98, v125, 0, s[48:49]
    v_cndmask_b32 v99, v125, 0, s[50:51]
    v_cndmask_b32 v100, v125, 0, s[52:53]
    v_cndmask_b32 v101, v125, 0, s[54:55]
    v_mbcnt_lo_u32_b32 v98, s48, v98
    v_mbcnt_lo_u32_b32 v99, s50, v99
    v_mbcnt_lo_u32_b32 v100, s52, v100
    v_mbcnt_lo_u32_b32 v101, s54, v101
    v_mbcnt_hi_u32_b32 v98, s49, v98
    v_mbcnt_hi_u32_b32 v99, s51, v99
    v_mbcnt_hi_u32_b32 v100, s53, v100
    v_mbcnt_hi_u32_b32 v101, s55, v101
    v_lshl_add_u64 v[98:99], v[98:99], 2, s[40:41]
    v_lshl_add_u64 v[100:101], v[100:101], 2, s[40:41]
    ds_write_b32 v98, v106
    ds_write_b32 v99, v107 offset:256
    ds_write_b32 v100, v108 offset:512
    ds_write_b32 v101, v109 offset:768
    s_bcnt1_i32_b64 s56, s[48:49]
    s_bcnt1_i32_b64 s57, s[50:51]
    s_bcnt1_i32_b64 s58, s[52:53]
    s_bcnt1_i32_b64 s59, s[54:55]
    s_max_u32 s43, s56, s57
    s_max_u32 s48, s58, s59
    s_max_u32 s43, s43, s48
    s_add_u32 m0, s36, 4096
    s_nop 0
    buffer_load_dwordx4 v1, s[20:23], s38 offen lds
    buffer_load_dwordx4 v1, s[20:23], s38 offen offset:1024 lds
    s_mov_b64 exec, 0xffff
    buffer_load_dwordx4 v1, s[20:23], s38 offen offset:2048 lds
    s_mov_b64 exec, -1
    ds_read_b64 v[98:99], v5
    ds_read_b64 v[100:101], v5 offset:256
    ds_read_b64 v[102:103], v5 offset:512
    ds_read_b64 v[104:105], v5 offset:768
    s_waitcnt lgkmcnt(14)
    v_pk_fma_f32 v[82:83], v[66:67], v[54:55], v[50:51]
    v_pk_fma_f32 v[84:85], v[68:69], v[56:57], v[52:53]
    v_pk_fma_f32 v[86:87], v[70:71], v[54:55], v[50:51]
    v_pk_fma_f32 v[88:89], v[72:73], v[56:57], v[52:53]
    s_waitcnt lgkmcnt(13)
    v_pk_fma_f32 v[90:91], v[74:75], v[54:55], v[50:51]
    v_pk_fma_f32 v[92:93], v[76:77], v[56:57], v[52:53]
    s_waitcnt lgkmcnt(12)
    v_pk_fma_f32 v[94:95], v[78:79], v[54:55], v[50:51]
    v_pk_fma_f32 v[96:97], v[80:81], v[56:57], v[52:53]
    ds_read_b64 v[106:107], v6
    ds_read_b64 v[108:109], v6 offset:256
    ds_read_b64 v[110:111], v6 offset:512
    ds_read_b64 v[112:113], v6 offset:768
    ds_read_u16_d16_hi v114, v7 offset:2
    ds_read_u16_d16_hi v115, v7 offset:514
    ds_read_b128 v[122:125], v121 offset:3200
    s_waitcnt lgkmcnt(15)
    v_mfma_f32_16x16x32_bf16 v[26:29], v[58:61], v[66:69], v[62:65]
    v_mfma_f32_16x16x32_bf16 v[30:33], v[58:61], v[70:73], v[62:65]
    v_mfma_f32_16x16x32_bf16 v[34:37], v[58:61], v[74:77], v[62:65]
    v_mfma_f32_16x16x32_bf16 v[38:41], v[58:61], v[78:81], v[62:65]
    v_cvt_pk_bf16_f32 v18, v82, v83
    v_cvt_pk_bf16_f32 v19, v84, v85
    v_cvt_pk_bf16_f32 v20, v86, v87
    v_cvt_pk_bf16_f32 v21, v88, v89
    v_cvt_pk_bf16_f32 v22, v90, v91
    v_cvt_pk_bf16_f32 v23, v92, v93
    v_cvt_pk_bf16_f32 v24, v94, v95
    v_cvt_pk_bf16_f32 v25, v96, v97
    s_waitcnt lgkmcnt(10)
    v_add_u32_sdwa v98, v98, v2 dst_sel:DWORD dst_unused:UNUSED_PAD src0_sel:WORD_0 src1_sel:DWORD
    v_add_u32_sdwa v99, v99, v2 dst_sel:DWORD dst_unused:UNUSED_PAD src0_sel:WORD_0 src1_sel:DWORD
    s_waitcnt lgkmcnt(9)
    v_add_u32_sdwa v100, v100, v2 dst_sel:DWORD dst_unused:UNUSED_PAD src0_sel:WORD_0 src1_sel:DWORD
    v_add_u32_sdwa v101, v101, v2 dst_sel:DWORD dst_unused:UNUSED_PAD src0_sel:WORD_0 src1_sel:DWORD
    s_waitcnt lgkmcnt(8)
    v_add_u32_sdwa v102, v102, v2 dst_sel:DWORD dst_unused:UNUSED_PAD src0_sel:WORD_0 src1_sel:DWORD
    v_add_u32_sdwa v103, v103, v2 dst_sel:DWORD dst_unused:UNUSED_PAD src0_sel:WORD_0 src1_sel:DWORD
    s_waitcnt lgkmcnt(7)
    v_add_u32_sdwa v104, v104, v2 dst_sel:DWORD dst_unused:UNUSED_PAD src0_sel:WORD_0 src1_sel:DWORD
    v_add_u32_sdwa v105, v105, v2 dst_sel:DWORD dst_unused:UNUSED_PAD src0_sel:WORD_0 src1_sel:DWORD
    s_waitcnt vmcnt(5)
    ds_read_b64 v[50:51], v98
    ds_read_b64 v[52:53], v99
    s_waitcnt lgkmcnt(8)
    v_add_u32_sdwa v106, v106, v4 dst_sel:DWORD dst_unused:UNUSED_PAD src0_sel:WORD_0 src1_sel:DWORD
    v_add_u32_sdwa v107, v107, v4 dst_sel:DWORD dst_unused:UNUSED_PAD src0_sel:WORD_0 src1_sel:DWORD
    s_waitcnt lgkmcnt(7)
    v_add_u32_sdwa v108, v108, v4 dst_sel:DWORD dst_unused:UNUSED_PAD src0_sel:WORD_0 src1_sel:DWORD
    v_add_u32_sdwa v109, v109, v4 dst_sel:DWORD dst_unused:UNUSED_PAD src0_sel:WORD_0 src1_sel:DWORD
    s_waitcnt lgkmcnt(6)
    v_add_u32_sdwa v110, v110, v4 dst_sel:DWORD dst_unused:UNUSED_PAD src0_sel:WORD_0 src1_sel:DWORD
    v_add_u32_sdwa v111, v111, v4 dst_sel:DWORD dst_unused:UNUSED_PAD src0_sel:WORD_0 src1_sel:DWORD
    s_waitcnt lgkmcnt(5)
    v_add_u32_sdwa v112, v112, v4 dst_sel:DWORD dst_unused:UNUSED_PAD src0_sel:WORD_0 src1_sel:DWORD
    v_add_u32_sdwa v113, v113, v4 dst_sel:DWORD dst_unused:UNUSED_PAD src0_sel:WORD_0 src1_sel:DWORD
    s_waitcnt lgkmcnt(1)
    v_mfma_f32_16x16x16_bf16 v[58:61], v[18:19], v[50:51], v[26:29]
    s_waitcnt lgkmcnt(0)
    v_mfma_f32_16x16x16_bf16 v[62:65], v[18:19], v[52:53], v[26:29]
    s_nop 5
    v_exp_f32_e64 v94, v58 clamp
    v_exp_f32_e64 v96, v59 clamp
    v_exp_f32_e64 v58, v60 clamp
    v_exp_f32_e64 v95, v62 clamp
    v_exp_f32_e64 v97, v63 clamp
    v_exp_f32_e64 v62, v61 clamp
    v_exp_f32_e64 v59, v64 clamp
    v_exp_f32_e64 v63, v65 clamp
    s_waitcnt vmcnt(3)
    ds_read_b64 v[54:55], v100 offset:1600
    ds_read_b64 v[56:57], v101 offset:1600
    v_pk_fma_f32 v[94:95], v[94:95], v[8:9], v[8:9] op_sel:[0,0,1] op_sel_hi:[1,0,1]
    v_pk_fma_f32 v[96:97], v[96:97], v[10:11], v[10:11] op_sel:[0,0,1] op_sel_hi:[1,0,1]
    v_pk_fma_f32 v[58:59], v[58:59], v[122:123], v[122:123] op_sel:[0,0,1] op_sel_hi:[1,0,1]
    v_pk_fma_f32 v[62:63], v[62:63], v[124:125], v[124:125] op_sel:[0,0,1] op_sel_hi:[1,0,1]
    v_pk_mul_f32 v[64:65], v[94:95], v[96:97]
    v_pk_add_f32 v[60:61], v[94:95], v[96:97]
    v_pk_mul_f32 v[94:95], v[64:65], v[58:59]
    v_pk_fma_f32 v[60:61], v[60:61], v[58:59], v[64:65]
    v_pk_mul_f32 v[96:97], v[94:95], v[62:63]
    v_rcp_f32 v96, v96
    v_rcp_f32 v97, v97
    v_pk_fma_f32 v[60:61], v[60:61], v[62:63], v[94:95]
    v_pk_mul_f32 v[90:91], v[60:61], v[96:97]
    s_waitcnt lgkmcnt(1)
    v_mfma_f32_16x16x16_bf16 v[66:69], v[20:21], v[54:55], v[30:33]
    s_waitcnt lgkmcnt(0)
    v_mfma_f32_16x16x16_bf16 v[70:73], v[20:21], v[56:57], v[30:33]
    s_nop 5
    v_exp_f32_e64 v94, v66 clamp
    v_exp_f32_e64 v96, v67 clamp
    v_exp_f32_e64 v66, v68 clamp
    v_exp_f32_e64 v95, v70 clamp
    v_exp_f32_e64 v97, v71 clamp
    v_exp_f32_e64 v70, v69 clamp
    v_exp_f32_e64 v67, v72 clamp
    v_exp_f32_e64 v71, v73 clamp
    s_waitcnt vmcnt(2)
    ds_read_b64 v[50:51], v102 offset:3200
    ds_read_b64 v[52:53], v103 offset:3200
    ds_read_b64_tr_b16 v[74:75], v106
    ds_read_b64_tr_b16 v[76:77], v107
    ds_read_b64_tr_b16 v[78:79], v108 offset:1600
    ds_read_b64_tr_b16 v[80:81], v109 offset:1600
    v_pk_fma_f32 v[94:95], v[94:95], v[8:9], v[8:9] op_sel:[0,0,1] op_sel_hi:[1,0,1]
    v_pk_fma_f32 v[96:97], v[96:97], v[10:11], v[10:11] op_sel:[0,0,1] op_sel_hi:[1,0,1]
    v_pk_fma_f32 v[66:67], v[66:67], v[122:123], v[122:123] op_sel:[0,0,1] op_sel_hi:[1,0,1]
    v_pk_fma_f32 v[70:71], v[70:71], v[124:125], v[124:125] op_sel:[0,0,1] op_sel_hi:[1,0,1]
    v_pk_mul_f32 v[72:73], v[94:95], v[96:97]
    v_pk_add_f32 v[68:69], v[94:95], v[96:97]
    v_pk_mul_f32 v[94:95], v[72:73], v[66:67]
    v_pk_fma_f32 v[68:69], v[68:69], v[66:67], v[72:73]
    v_pk_mul_f32 v[96:97], v[94:95], v[70:71]
    v_rcp_f32 v96, v96
    v_rcp_f32 v97, v97
    v_pk_fma_f32 v[68:69], v[68:69], v[70:71], v[94:95]
    v_pk_mul_f32 v[68:69], v[68:69], v[96:97]
    v_cvt_pk_bf16_f32 v90, v90, v68
    v_cvt_pk_bf16_f32 v91, v91, v69
    s_waitcnt lgkmcnt(5)
    v_mfma_f32_16x16x16_bf16 v[58:61], v[22:23], v[50:51], v[34:37]
    s_waitcnt lgkmcnt(4)
    v_mfma_f32_16x16x16_bf16 v[62:65], v[22:23], v[52:53], v[34:37]
    v_mfma_f32_16x16x16_bf16 v[86:89], v[12:13], v[90:91], v[14:17]
    s_nop 4
    v_exp_f32_e64 v94, v58 clamp
    v_exp_f32_e64 v96, v59 clamp
    v_exp_f32_e64 v58, v60 clamp
    v_exp_f32_e64 v95, v62 clamp
    v_exp_f32_e64 v97, v63 clamp
    v_exp_f32_e64 v62, v61 clamp
    v_exp_f32_e64 v59, v64 clamp
    v_exp_f32_e64 v63, v65 clamp
    v_mul_f32 v116, v86, v114
    v_cvt_pk_bf16_f32 v116, v116, v116
    ds_write_b16 v15, v116 offset:7424
    ds_read2_b64 v[82:85], v16 offset0:0 offset1:8
    v_pk_fma_f32 v[94:95], v[94:95], v[8:9], v[8:9] op_sel:[0,0,1] op_sel_hi:[1,0,1]
    v_pk_fma_f32 v[96:97], v[96:97], v[10:11], v[10:11] op_sel:[0,0,1] op_sel_hi:[1,0,1]
    v_pk_fma_f32 v[58:59], v[58:59], v[122:123], v[122:123] op_sel:[0,0,1] op_sel_hi:[1,0,1]
    v_pk_fma_f32 v[62:63], v[62:63], v[124:125], v[124:125] op_sel:[0,0,1] op_sel_hi:[1,0,1]
    v_pk_mul_f32 v[64:65], v[94:95], v[96:97]
    v_pk_add_f32 v[60:61], v[94:95], v[96:97]
    v_pk_mul_f32 v[94:95], v[64:65], v[58:59]
    v_pk_fma_f32 v[60:61], v[60:61], v[58:59], v[64:65]
    v_pk_mul_f32 v[96:97], v[94:95], v[62:63]
    v_rcp_f32 v96, v96
    v_rcp_f32 v97, v97
    v_pk_fma_f32 v[60:61], v[60:61], v[62:63], v[94:95]
    v_pk_mul_f32 v[92:93], v[60:61], v[96:97]
    s_waitcnt lgkmcnt(0)
    v_mfma_f32_16x16x32_bf16 v[42:45], v[74:77], v[82:85], 0
    v_mfma_f32_16x16x32_bf16 v[46:49], v[78:81], v[82:85], 0
    s_waitcnt vmcnt(0)
    ds_read_b64 v[54:55], v104 offset:4800
    ds_read_b64 v[56:57], v105 offset:4800
    ds_read_b64_tr_b16 v[74:75], v110 offset:3200
    ds_read_b64_tr_b16 v[76:77], v111 offset:3200
    ds_read_b64_tr_b16 v[78:79], v112 offset:4800
    ds_read_b64_tr_b16 v[80:81], v113 offset:4800
    s_waitcnt lgkmcnt(5)
    v_mfma_f32_16x16x16_bf16 v[66:69], v[24:25], v[54:55], v[38:41]
    s_waitcnt lgkmcnt(4)
    v_mfma_f32_16x16x16_bf16 v[70:73], v[24:25], v[56:57], v[38:41]
    s_nop 5
    v_exp_f32_e64 v94, v66 clamp
    v_exp_f32_e64 v96, v67 clamp
    v_exp_f32_e64 v66, v68 clamp
    v_exp_f32_e64 v95, v70 clamp
    v_exp_f32_e64 v97, v71 clamp
    v_exp_f32_e64 v70, v69 clamp
    v_exp_f32_e64 v67, v72 clamp
    v_exp_f32_e64 v71, v73 clamp
    v_pk_fma_f32 v[94:95], v[94:95], v[8:9], v[8:9] op_sel:[0,0,1] op_sel_hi:[1,0,1]
    v_pk_fma_f32 v[96:97], v[96:97], v[10:11], v[10:11] op_sel:[0,0,1] op_sel_hi:[1,0,1]
    v_pk_fma_f32 v[66:67], v[66:67], v[122:123], v[122:123] op_sel:[0,0,1] op_sel_hi:[1,0,1]
    v_pk_fma_f32 v[70:71], v[70:71], v[124:125], v[124:125] op_sel:[0,0,1] op_sel_hi:[1,0,1]
    v_pk_mul_f32 v[72:73], v[94:95], v[96:97]
    v_pk_add_f32 v[68:69], v[94:95], v[96:97]
    v_pk_mul_f32 v[94:95], v[72:73], v[66:67]
    v_pk_fma_f32 v[68:69], v[68:69], v[66:67], v[72:73]
    v_pk_mul_f32 v[96:97], v[94:95], v[70:71]
    v_rcp_f32 v96, v96
    v_rcp_f32 v97, v97
    v_pk_fma_f32 v[68:69], v[68:69], v[70:71], v[94:95]
    v_pk_mul_f32 v[68:69], v[68:69], v[96:97]
    v_cvt_pk_bf16_f32 v92, v92, v68
    v_cvt_pk_bf16_f32 v93, v93, v69
    s_nop 1
    v_mfma_f32_16x16x16_bf16 v[86:89], v[12:13], v[92:93], v[14:17]
    s_nop 7
    v_mul_f32 v116, v86, v115
    v_cvt_pk_bf16_f32 v116, v116, v116
    ds_write_b16 v15, v116 offset:7552
    ds_read2_b64 v[82:85], v16 offset0:16 offset1:24
    s_waitcnt lgkmcnt(0)
    v_mfma_f32_16x16x32_bf16 v[102:105], v[74:77], v[82:85], 0
    v_mfma_f32_16x16x32_bf16 v[110:113], v[78:81], v[82:85], 0
    s_cmp_gt_u32 s43, 32
    s_cbranch_scc1 L_slowL
    s_branch L_back
L_path1:
    v_lshrrev_b32 v116, 6, v0
    v_and_b32 v110, 63, v0
    v_readfirstlane_b32 s3, v116
    v_add_u32 v113, v0, v0
    v_add_u32 v111, v110, v110
    v_add_u32 v112, v110, v110
    v_lshlrev_b32 v1, 4, v110
    v_and_b32 v114, 15, v110
    v_lshrrev_b32 v115, 4, v110
    v_mov_b32 v119, 0
    v_add_u32 v117, v114, v114
    s_mul_i32 s36, s3, 7936
    s_add_u32 s36, s36, 3456
    s_mul_i32 s32, s2, 4
    s_add_u32 s32, s32, s3
    s_mul_i32 s33, s32, 6400
    s_mul_i32 s34, s32, 400
    s_lshl_b32 s35, s32, 7
    s_add_u32 s41, s36, 6400
    s_mov_b32 s40, s41
    s_mov_b32 s37, 0xbfb8aa3b
    s_mov_b32 s22, 26214400
    s_mov_b32 s23, 0x20000
    s_mov_b32 s26, 1638400
    s_mov_b32 s27, 0x20000
    s_mov_b32 s30, 524288
    s_mov_b32 s31, 0x20000
    s_mov_b32 s46, 524288
    s_mov_b32 s47, 0x20000
    s_mov_b32 m0, s36
    s_mov_b32 s42, s3
    v_add_u32 v124, v1, v1
    s_mov_b32 exec_lo, 0
    s_mov_b32 exec_hi, 0xfffc0000
    v_mov_b32 v112, 0x7ff00000
    v_mov_b32 v124, 1568
    s_mov_b64 exec, -1
    s_waitcnt lgkmcnt(0)
    s_load_dwordx8 s[72:79], s[14:15], 0
    s_mov_b32 s20, s6
    s_and_b32 s21, s7, 0xffff
    s_add_u32 s38, s33, 3200
    s_cmp_lg_u32 s42, 0
    s_cbranch_scc1 L_nb1
    global_load_short_d16_hi v105, v119, s[16:17]
    global_load_short_d16_hi v102, v117, s[12:13]
    global_load_short_d16_hi v103, v117, s[14:15]
L_nb1:
    s_mov_b32 s24, s8
    s_and_b32 s25, s9, 0xffff
    s_mov_b32 m0, s41
    s_mov_b32 exec_lo, 0x1ffffff
    s_mov_b32 exec_hi, 0
    buffer_load_dwordx4 v1, s[24:27], s34 offen lds
    s_mov_b64 exec, -1
    s_mov_b32 m0, s36
    v_mov_b32 v106, 0
    v_mov_b32 v107, 0
    v_mov_b32 v108, 0
    v_mov_b32 v109, 0
    global_load_short_d16_hi v98, v113, s[10:11]
    global_load_short_d16_hi v99, v113, s[10:11] offset:512
    global_load_short_d16_hi v100, v113, s[10:11] offset:1024
    global_load_short_d16_hi v101, v113, s[10:11] offset:1536
    s_mov_b32 s44, s4
    s_and_b32 s45, s5, 0xffff
    buffer_load_short_d16_hi v104, v111, s[44:47], s35 offen
    s_mov_b32 s28, s18
    s_and_b32 s29, s19, 0xffff
    s_mov_b32 s39, 0xffff
    s_lshl_b32 s49, s3, 8
    s_mov_b32 s56, 0x3380
    s_mov_b32 s57, 0
    v_sub_u32 v125, 63, v110
    v_lshlrev_b32 v116, 3, v115
    v_lshl_add_u32 v17, v114, 5, v116
    v_add_u32 v121, v116, v116
    v_add_u32 v122, s36, v121
    v_add_u32 v15, s36, v111
    v_add_u32 v123, v15, v111
    s_add_u32 s50, s36, 7424
    v_and_b32 v119, 0x38, v17
    v_add_u32 v16, s50, v119
    v_and_b32 v119, 16, v111
    v_xad_u32 v2, v17, v119, s36
    v_lshrrev_b32 v119, 1, v110
    v_lshl_add_u32 v5, v119, 2, s41
    v_and_b32 v119, 16, v119
    v_lshrrev_b32 v116, 1, v1
    v_xad_u32 v4, v116, v119, s36
    v_xor_b32 v6, v1, v110
    v_and_b32 v6, 16, v6
    v_lshl_add_u32 v7, v119, 2, s41
    v_lshl_add_u32 v7, v114, 2, v7
    v_and_b32 v119, 16, v110
    v_lshl_add_u32 v7, v119, 4, v7
    v_lshl_add_u32 v119, v114, 4, s49
    v_lshl_add_u32 v120, v115, 2, v119
    v_lshlrev_b32 v118, 2, v114
    v_and_b32 v116, 2, v114
    v_lshlrev_b32 v116, 5, v116
    v_and_b32 v119, 12, v114
    v_lshl_add_u32 v116, v119, 2, v116
    v_and_b32 v119, 1, v114
    v_lshl_add_u32 v116, v119, 3, v116
    s_waitcnt lgkmcnt(0)
    s_and_b32 s4, s72, 0x7f807f80
    s_and_b32 s5, s73, 0x7f807f80
    s_and_b32 s6, s74, 0x7f807f80
    s_and_b32 s7, s75, 0x7f807f80
    s_and_b32 s8, s76, 0x7f807f80
    s_and_b32 s9, s77, 0x7f807f80
    s_and_b32 s10, s78, 0x7f807f80
    s_and_b32 s11, s79, 0x7f807f80
    s_lshl_b32 s12, s4, 16
    s_lshl_b32 s13, s5, 16
    s_lshl_b32 s14, s6, 16
    s_lshl_b32 s15, s7, 16
    s_lshl_b32 s16, s8, 16
    s_lshl_b32 s17, s9, 16
    s_lshl_b32 s18, s10, 16
    s_lshl_b32 s19, s11, 16
    s_max_u32 s4, s4, s12
    s_max_u32 s5, s5, s13
    s_max_u32 s6, s6, s14
    s_max_u32 s7, s7, s15
    s_max_u32 s8, s8, s16
    s_max_u32 s9, s9, s17
    s_max_u32 s10, s10, s18
    s_max_u32 s11, s11, s19
    s_max_u32 s4, s4, s8
    s_max_u32 s5, s5, s9
    s_max_u32 s6, s6, s10
    s_max_u32 s7, s7, s11
    s_max_u32 s4, s4, s6
    s_max_u32 s5, s5, s7
    s_max_u32 s4, s4, s5
    s_and_b32 s4, s4, 0x7f800000
    s_max_u32 s4, s4, 0xc800000
    s_min_u32 s4, s4, 0x7e800000
    s_sub_u32 s5, 0x7f000000, s4
    s_lshr_b32 s56, s4, 16
    s_sub_u32 s56, s56, 0xc00
    s_mov_b32 s6, 0x7fffffff
    s_mov_b32 s7, 0x31800000
    s_mov_b32 s8, 0xc1c00000
    v_lshlrev_b64 v[12:13], v123, s[56:57]
    s_waitcnt vmcnt(5)
    s_mov_b32 exec_hi, 0x3ffff
    ds_read_u16_d16_hi v106, v15 offset:6400
    ds_read_u16_d16_hi v107, v15 offset:6500
    ds_read_u16_d16_hi v108, v15 offset:6600
    ds_read_u16_d16_hi v109, v15 offset:6700
    s_mov_b32 exec_hi, -1
    s_waitcnt lgkmcnt(3)
    v_cmp_lt_u32 s[48:49], s39, v106
    s_waitcnt lgkmcnt(2)
    v_cmp_lt_u32 s[50:51], s39, v107
    s_waitcnt lgkmcnt(1)
    v_cmp_lt_u32 s[52:53], s39, v108
    s_waitcnt lgkmcnt(0)
    v_cmp_lt_u32 s[54:55], s39, v109
    v_or_b32 v106, v124, v106
    v_or_b32 v107, v124, v107
    v_or_b32 v108, v124, v108
    v_or_b32 v109, v124, v109
    v_cndmask_b32 v66, v125, 0, s[48:49]
    v_cndmask_b32 v67, v125, 0, s[50:51]
    v_cndmask_b32 v68, v125, 0, s[52:53]
    v_cndmask_b32 v69, v125, 0, s[54:55]
    v_mbcnt_lo_u32_b32 v66, s48, v66
    v_mbcnt_lo_u32_b32 v67, s50, v67
    v_mbcnt_lo_u32_b32 v68, s52, v68
    v_mbcnt_lo_u32_b32 v69, s54, v69
    v_mbcnt_hi_u32_b32 v66, s49, v66
    v_mbcnt_hi_u32_b32 v67, s51, v67
    v_mbcnt_hi_u32_b32 v68, s53, v68
    v_mbcnt_hi_u32_b32 v69, s55, v69
    v_lshl_add_u64 v[66:67], v[66:67], 2, s[40:41]
    v_lshl_add_u64 v[68:69], v[68:69], 2, s[40:41]
    ds_write_b32 v66, v106
    ds_write_b32 v67, v107 offset:256
    ds_write_b32 v68, v108 offset:512
    ds_write_b32 v69, v109 offset:768
    s_bcnt1_i32_b64 s56, s[48:49]
    s_bcnt1_i32_b64 s57, s[50:51]
    s_bcnt1_i32_b64 s58, s[52:53]
    s_bcnt1_i32_b64 s59, s[54:55]
    s_max_u32 s43, s56, s57
    s_max_u32 s48, s58, s59
    s_max_u32 s43, s43, s48
    ds_read2st64_b32 v[106:107], v5 offset0:0 offset1:1
    ds_read2st64_b32 v[108:109], v5 offset0:2 offset1:3
    s_waitcnt lgkmcnt(1)
    v_add_u32_sdwa v106, v106, v6 dst_sel:DWORD dst_unused:UNUSED_PAD src0_sel:WORD_0 src1_sel:DWORD
    v_add_u32_sdwa v107, v107, v6 dst_sel:DWORD dst_unused:UNUSED_PAD src0_sel:WORD_0 src1_sel:DWORD
    s_waitcnt lgkmcnt(0)
    v_add_u32_sdwa v108, v108, v6 dst_sel:DWORD dst_unused:UNUSED_PAD src0_sel:WORD_0 src1_sel:DWORD
    v_add_u32_sdwa v109, v109, v6 dst_sel:DWORD dst_unused:UNUSED_PAD src0_sel:WORD_0 src1_sel:DWORD
    buffer_load_dwordx4 v106, s[20:23], s33 offen lds
    buffer_load_dwordx4 v107, s[20:23], s33 offen offset:1600 lds
    s_add_u32 m0, s36, 3200
    s_nop 0
    buffer_load_dwordx4 v108, s[20:23], s38 offen lds
    buffer_load_dwordx4 v109, s[20:23], s38 offen offset:1600 lds
    s_waitcnt vmcnt(6)
    v_add_f32 v98, v98, v100
    v_sub_f32 v99, v99, v100
    v_mul_f32 v98, s37, v98
    v_mul_f32 v99, s37, v99
    s_waitcnt vmcnt(5)
    v_mul_f32 v101, s37, v101
    ds_write_b32 v120, v98
    v_cvt_pk_bf16_f32 v117, v99, v99
    ds_write_b32 v120, v101 offset:1024
    ds_write_b32 v120, v117 offset:2048
    s_cmp_lg_u32 s42, 0
    s_cbranch_scc1 L_np1
    v_mul_f32 v103, s5, v103
    v_mul_f32 v102, s37, v102
    v_max_f32_e64 v82, |v103|, s7
    v_bfi_b32 v82, s6, v82, v103
    v_rcp_f32 v86, v82
    v_add_f32 v102, s8, v102
    v_mul_f32 v87, 0x33800000, v86
    s_mov_b64 exec, 0xffff
    ds_write_b32 v118, v102 offset:3072
    ds_write_b64 v116, v[86:87] offset:3136
    ds_write_b32 v118, v105 offset:3264
    s_mov_b64 exec, -1
L_np1:
    s_waitcnt vmcnt(4)
    ds_write_b32 v123, v104 offset:7680
    s_waitcnt lgkmcnt(0)
    s_barrier
    ds_read_b128 v[66:69], v122 offset:7680
    ds_read_b128 v[70:73], v122 offset:7744
    ds_read_b128 v[50:53], v1
    ds_read_b128 v[54:57], v1 offset:1024
    ds_read_b128 v[74:77], v122 offset:7808
    ds_read_b128 v[78:81], v122 offset:7872
    ds_read_b128 v[58:61], v1 offset:2048
    ds_read_b128 v[62:65], v121 offset:3072
    ds_read_b128 v[8:11], v121 offset:3136
    ds_read_b32 v14, v121 offset:3264
    s_waitcnt lgkmcnt(6)
    v_pk_fma_f32 v[82:83], v[66:67], v[54:55], v[50:51]
    v_pk_fma_f32 v[84:85], v[68:69], v[56:57], v[52:53]
    v_pk_fma_f32 v[86:87], v[70:71], v[54:55], v[50:51]
    v_pk_fma_f32 v[88:89], v[72:73], v[56:57], v[52:53]
    s_waitcnt lgkmcnt(5)
    v_pk_fma_f32 v[90:91], v[74:75], v[54:55], v[50:51]
    v_pk_fma_f32 v[92:93], v[76:77], v[56:57], v[52:53]
    s_waitcnt lgkmcnt(4)
    v_pk_fma_f32 v[94:95], v[78:79], v[54:55], v[50:51]
    v_pk_fma_f32 v[96:97], v[80:81], v[56:57], v[52:53]
    ds_read_u16_d16_hi v114, v7 offset:2
    ds_read_u16_d16_hi v115, v7 offset:514
    ds_read_b128 v[122:125], v121 offset:3200
    s_waitcnt lgkmcnt(5)
    v_mfma_f32_16x16x32_bf16 v[26:29], v[58:61], v[66:69], v[62:65]
    v_mfma_f32_16x16x32_bf16 v[30:33], v[58:61], v[70:73], v[62:65]
    v_mfma_f32_16x16x32_bf16 v[34:37], v[58:61], v[74:77], v[62:65]
    v_mfma_f32_16x16x32_bf16 v[38:41], v[58:61], v[78:81], v[62:65]
    v_cvt_pk_bf16_f32 v18, v82, v83
    v_cvt_pk_bf16_f32 v19, v84, v85
    v_cvt_pk_bf16_f32 v20, v86, v87
    v_cvt_pk_bf16_f32 v21, v88, v89
    v_cvt_pk_bf16_f32 v22, v90, v91
    v_cvt_pk_bf16_f32 v23, v92, v93
    v_cvt_pk_bf16_f32 v24, v94, v95
    v_cvt_pk_bf16_f32 v25, v96, v97
    s_cmp_gt_u32 s43, 32
    s_cbranch_scc1 L_xd1
L_xb1:
    s_waitcnt vmcnt(3)
    ds_read_b64 v[50:51], v2
    ds_read_b64 v[52:53], v2 offset:512
    s_waitcnt lgkmcnt(1)
    v_mfma_f32_16x16x16_bf16 v[58:61], v[18:19], v[50:51], v[26:29]
    s_waitcnt lgkmcnt(0)
    v_mfma_f32_16x16x16_bf16 v[62:65], v[18:19], v[52:53], v[26:29]
    s_nop 5
    v_exp_f32_e64 v94, v58 clamp
    v_exp_f32_e64 v96, v59 clamp
    v_exp_f32_e64 v58, v60 clamp
    v_exp_f32_e64 v95, v62 clamp
    v_exp_f32_e64 v97, v63 clamp
    v_exp_f32_e64 v62, v61 clamp
    v_exp_f32_e64 v59, v64 clamp
    v_exp_f32_e64 v63, v65 clamp
    s_waitcnt vmcnt(2)
    ds_read_b64 v[54:55], v2 offset:1600
    ds_read_b64 v[56:57], v2 offset:2112
    v_pk_fma_f32 v[94:95], v[94:95], v[8:9], v[8:9] op_sel:[0,0,1] op_sel_hi:[1,0,1]
    v_pk_fma_f32 v[96:97], v[96:97], v[10:11], v[10:11] op_sel:[0,0,1] op_sel_hi:[1,0,1]
    v_pk_fma_f32 v[58:59], v[58:59], v[122:123], v[122:123] op_sel:[0,0,1] op_sel_hi:[1,0,1]
    v_pk_fma_f32 v[62:63], v[62:63], v[124:125], v[124:125] op_sel:[0,0,1] op_sel_hi:[1,0,1]
    v_pk_mul_f32 v[64:65], v[94:95], v[96:97]
    v_pk_add_f32 v[60:61], v[94:95], v[96:97]
    v_pk_mul_f32 v[94:95], v[64:65], v[58:59]
    v_pk_fma_f32 v[60:61], v[60:61], v[58:59], v[64:65]
    v_pk_mul_f32 v[96:97], v[94:95], v[62:63]
    v_rcp_f32 v96, v96
    v_rcp_f32 v97, v97
    v_pk_fma_f32 v[60:61], v[60:61], v[62:63], v[94:95]
    v_pk_mul_f32 v[90:91], v[60:61], v[96:97]
    s_waitcnt lgkmcnt(1)
    v_mfma_f32_16x16x16_bf16 v[66:69], v[20:21], v[54:55], v[30:33]
    s_waitcnt lgkmcnt(0)
    v_mfma_f32_16x16x16_bf16 v[70:73], v[20:21], v[56:57], v[30:33]
    s_nop 5
    v_exp_f32_e64 v94, v66 clamp
    v_exp_f32_e64 v96, v67 clamp
    v_exp_f32_e64 v66, v68 clamp
    v_exp_f32_e64 v95, v70 clamp
    v_exp_f32_e64 v97, v71 clamp
    v_exp_f32_e64 v70, v69 clamp
    v_exp_f32_e64 v67, v72 clamp
    v_exp_f32_e64 v71, v73 clamp
    s_waitcnt vmcnt(1)
    ds_read_b64 v[50:51], v2 offset:3200
    ds_read_b64 v[52:53], v2 offset:3712
    ds_read_b64_tr_b16 v[74:75], v4
    ds_read_b64_tr_b16 v[76:77], v4 offset:512
    ds_read_b64_tr_b16 v[78:79], v4 offset:1600
    ds_read_b64_tr_b16 v[80:81], v4 offset:2112
    v_pk_fma_f32 v[94:95], v[94:95], v[8:9], v[8:9] op_sel:[0,0,1] op_sel_hi:[1,0,1]
    v_pk_fma_f32 v[96:97], v[96:97], v[10:11], v[10:11] op_sel:[0,0,1] op_sel_hi:[1,0,1]
    v_pk_fma_f32 v[66:67], v[66:67], v[122:123], v[122:123] op_sel:[0,0,1] op_sel_hi:[1,0,1]
    v_pk_fma_f32 v[70:71], v[70:71], v[124:125], v[124:125] op_sel:[0,0,1] op_sel_hi:[1,0,1]
    v_pk_mul_f32 v[72:73], v[94:95], v[96:97]
    v_pk_add_f32 v[68:69], v[94:95], v[96:97]
    v_pk_mul_f32 v[94:95], v[72:73], v[66:67]
    v_pk_fma_f32 v[68:69], v[68:69], v[66:67], v[72:73]
    v_pk_mul_f32 v[96:97], v[94:95], v[70:71]
    v_rcp_f32 v96, v96
    v_rcp_f32 v97, v97
    v_pk_fma_f32 v[68:69], v[68:69], v[70:71], v[94:95]
    v_pk_mul_f32 v[68:69], v[68:69], v[96:97]
    v_cvt_pk_bf16_f32 v90, v90, v68
    v_cvt_pk_bf16_f32 v91, v91, v69
    s_waitcnt lgkmcnt(5)
    v_mfma_f32_16x16x16_bf16 v[58:61], v[22:23], v[50:51], v[34:37]
    s_waitcnt lgkmcnt(4)
    v_mfma_f32_16x16x16_bf16 v[62:65], v[22:23], v[52:53], v[34:37]
    v_mfma_f32_16x16x16_bf16 v[86:89], v[12:13], v[90:91], v[14:17]
    s_nop 4
    v_exp_f32_e64 v94, v58 clamp
    v_exp_f32_e64 v96, v59 clamp
    v_exp_f32_e64 v58, v60 clamp
    v_exp_f32_e64 v95, v62 clamp
    v_exp_f32_e64 v97, v63 clamp
    v_exp_f32_e64 v62, v61 clamp
    v_exp_f32_e64 v59, v64 clamp
    v_exp_f32_e64 v63, v65 clamp
    v_mul_f32 v116, v86, v114
    v_cvt_pk_bf16_f32 v116, v116, v116
    ds_write_b16 v15, v116 offset:7424
    ds_read2_b64 v[82:85], v16 offset0:0 offset1:8
    v_pk_fma_f32 v[94:95], v[94:95], v[8:9], v[8:9] op_sel:[0,0,1] op_sel_hi:[1,0,1]
    v_pk_fma_f32 v[96:97], v[96:97], v[10:11], v[10:11] op_sel:[0,0,1] op_sel_hi:[1,0,1]
    v_pk_fma_f32 v[58:59], v[58:59], v[122:123], v[122:123] op_sel:[0,0,1] op_sel_hi:[1,0,1]
    v_pk_fma_f32 v[62:63], v[62:63], v[124:125], v[124:125] op_sel:[0,0,1] op_sel_hi:[1,0,1]
    v_pk_mul_f32 v[64:65], v[94:95], v[96:97]
    v_pk_add_f32 v[60:61], v[94:95], v[96:97]
    v_pk_mul_f32 v[94:95], v[64:65], v[58:59]
    v_pk_fma_f32 v[60:61], v[60:61], v[58:59], v[64:65]
    v_pk_mul_f32 v[96:97], v[94:95], v[62:63]
    v_rcp_f32 v96, v96
    v_rcp_f32 v97, v97
    v_pk_fma_f32 v[60:61], v[60:61], v[62:63], v[94:95]
    v_pk_mul_f32 v[92:93], v[60:61], v[96:97]
    s_waitcnt lgkmcnt(0)
    v_mfma_f32_16x16x32_bf16 v[42:45], v[74:77], v[82:85], 0
    v_mfma_f32_16x16x32_bf16 v[46:49], v[78:81], v[82:85], 0
    s_waitcnt vmcnt(0)
    ds_read_b64 v[54:55], v2 offset:4800
    ds_read_b64 v[56:57], v2 offset:5312
    ds_read_b64_tr_b16 v[74:75], v4 offset:3200
    ds_read_b64_tr_b16 v[76:77], v4 offset:3712
    ds_read_b64_tr_b16 v[78:79], v4 offset:4800
    ds_read_b64_tr_b16 v[80:81], v4 offset:5312
    s_waitcnt lgkmcnt(5)
    v_mfma_f32_16x16x16_bf16 v[66:69], v[24:25], v[54:55], v[38:41]
    s_waitcnt lgkmcnt(4)
    v_mfma_f32_16x16x16_bf16 v[70:73], v[24:25], v[56:57], v[38:41]
    s_nop 5
    v_exp_f32_e64 v94, v66 clamp
    v_exp_f32_e64 v96, v67 clamp
    v_exp_f32_e64 v66, v68 clamp
    v_exp_f32_e64 v95, v70 clamp
    v_exp_f32_e64 v97, v71 clamp
    v_exp_f32_e64 v70, v69 clamp
    v_exp_f32_e64 v67, v72 clamp
    v_exp_f32_e64 v71, v73 clamp
    v_pk_fma_f32 v[94:95], v[94:95], v[8:9], v[8:9] op_sel:[0,0,1] op_sel_hi:[1,0,1]
    v_pk_fma_f32 v[96:97], v[96:97], v[10:11], v[10:11] op_sel:[0,0,1] op_sel_hi:[1,0,1]
    v_pk_fma_f32 v[66:67], v[66:67], v[122:123], v[122:123] op_sel:[0,0,1] op_sel_hi:[1,0,1]
    v_pk_fma_f32 v[70:71], v[70:71], v[124:125], v[124:125] op_sel:[0,0,1] op_sel_hi:[1,0,1]
    v_pk_mul_f32 v[72:73], v[94:95], v[96:97]
    v_pk_add_f32 v[68:69], v[94:95], v[96:97]
    v_pk_mul_f32 v[94:95], v[72:73], v[66:67]
    v_pk_fma_f32 v[68:69], v[68:69], v[66:67], v[72:73]
    v_pk_mul_f32 v[96:97], v[94:95], v[70:71]
    v_rcp_f32 v96, v96
    v_rcp_f32 v97, v97
    v_pk_fma_f32 v[68:69], v[68:69], v[70:71], v[94:95]
    v_pk_mul_f32 v[68:69], v[68:69], v[96:97]
    v_cvt_pk_bf16_f32 v92, v92, v68
    v_cvt_pk_bf16_f32 v93, v93, v69
    s_nop 1
    v_mfma_f32_16x16x16_bf16 v[86:89], v[12:13], v[92:93], v[14:17]
    s_nop 7
    v_mul_f32 v116, v86, v115
    v_cvt_pk_bf16_f32 v116, v116, v116
    ds_write_b16 v15, v116 offset:7552
    ds_read2_b64 v[82:85], v16 offset0:16 offset1:24
    s_waitcnt lgkmcnt(0)
    v_mfma_f32_16x16x32_bf16 v[102:105], v[74:77], v[82:85], 0
    v_mfma_f32_16x16x32_bf16 v[110:113], v[78:81], v[82:85], 0
    s_cmp_gt_u32 s43, 32
    s_cbranch_scc1 L_slowG
    s_branch L_back
L_path2:
    v_lshrrev_b32 v116, 6, v0
    v_and_b32 v110, 63, v0
    v_readfirstlane_b32 s3, v116
    v_add_u32 v113, v0, v0
    v_add_u32 v111, v110, v110
    v_add_u32 v112, v110, v110
    v_lshlrev_b32 v1, 4, v110
    v_and_b32 v114, 15, v110
    v_lshrrev_b32 v115, 4, v110
    v_mov_b32 v119, 0
    v_add_u32 v117, v114, v114
    s_mul_i32 s36, s3, 7936
    s_add_u32 s36, s36, 3456
    s_mul_i32 s32, s2, 4
    s_add_u32 s32, s32, s3
    s_mul_i32 s33, s32, 6400
    s_mul_i32 s34, s32, 400
    s_lshl_b32 s35, s32, 7
    s_add_u32 s41, s36, 6400
    s_mov_b32 s40, s41
    s_mov_b32 s37, 0xbfb8aa3b
    s_mov_b32 s22, 26214400
    s_mov_b32 s23, 0x20000
    s_mov_b32 s26, 1638400
    s_mov_b32 s27, 0x20000
    s_mov_b32 s30, 524288
    s_mov_b32 s31, 0x20000
    s_mov_b32 s46, 524288
    s_mov_b32 s47, 0x20000
    s_mov_b32 m0, s36
    s_mov_b32 s42, s3
    v_add_u32 v124, v1, v1
    s_mov_b32 exec_lo, 0
    s_mov_b32 exec_hi, 0xfffc0000
    v_mov_b32 v112, 0x7ff00000
    v_mov_b32 v124, 1568
    s_mov_b64 exec, -1
    s_waitcnt lgkmcnt(0)
    s_load_dwordx8 s[72:79], s[14:15], 0
    s_mov_b32 s20, s6
    s_and_b32 s21, s7, 0xffff
    s_add_u32 s38, s33, 3200
    s_cmp_lg_u32 s42, 0
    s_cbranch_scc1 L_nb2
    global_load_short_d16_hi v105, v119, s[16:17]
    global_load_short_d16_hi v102, v117, s[12:13]
    global_load_short_d16_hi v103, v117, s[14:15]
L_nb2:
    s_mov_b32 s24, s8
    s_and_b32 s25, s9, 0xffff
    s_mov_b32 m0, s41
    s_mov_b32 exec_lo, 0x1ffffff
    s_mov_b32 exec_hi, 0
    buffer_load_dwordx4 v1, s[24:27], s34 offen lds
    s_mov_b64 exec, -1
    s_mov_b32 m0, s36
    v_mov_b32 v106, 0
    v_mov_b32 v107, 0
    v_mov_b32 v108, 0
    v_mov_b32 v109, 0
    global_load_short_d16_hi v98, v113, s[10:11]
    global_load_short_d16_hi v99, v113, s[10:11] offset:512
    global_load_short_d16_hi v100, v113, s[10:11] offset:1024
    global_load_short_d16_hi v101, v113, s[10:11] offset:1536
    s_mov_b32 s44, s4
    s_and_b32 s45, s5, 0xffff
    buffer_load_short_d16_hi v104, v111, s[44:47], s35 offen
    s_mov_b32 s28, s18
    s_and_b32 s29, s19, 0xffff
    s_mov_b32 s39, 0xffff
    s_lshl_b32 s49, s3, 8
    s_mov_b32 s56, 0x3380
    s_mov_b32 s57, 0
    v_sub_u32 v125, 63, v110
    v_lshlrev_b32 v116, 3, v115
    v_lshl_add_u32 v17, v114, 5, v116
    v_add_u32 v121, v116, v116
    v_add_u32 v122, s36, v121
    v_add_u32 v15, s36, v111
    v_add_u32 v123, v15, v111
    s_add_u32 s50, s36, 7424
    v_and_b32 v119, 0x38, v17
    v_add_u32 v16, s50, v119
    v_and_b32 v119, 16, v111
    v_xad_u32 v2, v17, v119, s36
    v_lshrrev_b32 v119, 1, v110
    v_lshl_add_u32 v5, v119, 2, s41
    v_and_b32 v119, 16, v119
    v_lshrrev_b32 v116, 1, v1
    v_xad_u32 v4, v116, v119, s36
    v_xor_b32 v6, v1, v110
    v_and_b32 v6, 16, v6
    v_lshl_add_u32 v7, v119, 2, s41
    v_lshl_add_u32 v7, v114, 2, v7
    v_and_b32 v119, 16, v110
    v_lshl_add_u32 v7, v119, 4, v7
    v_lshl_add_u32 v119, v114, 4, s49
    v_lshl_add_u32 v120, v115, 2, v119
    v_lshlrev_b32 v118, 2, v114
    v_and_b32 v116, 2, v114
    v_lshlrev_b32 v116, 5, v116
    v_and_b32 v119, 12, v114
    v_lshl_add_u32 v116, v119, 2, v116
    v_and_b32 v119, 1, v114
    v_lshl_add_u32 v116, v119, 3, v116
    s_waitcnt lgkmcnt(0)
    s_and_b32 s4, s72, 0x7f807f80
    s_and_b32 s5, s73, 0x7f807f80
    s_and_b32 s6, s74, 0x7f807f80
    s_and_b32 s7, s75, 0x7f807f80
    s_and_b32 s8, s76, 0x7f807f80
    s_and_b32 s9, s77, 0x7f807f80
    s_and_b32 s10, s78, 0x7f807f80
    s_and_b32 s11, s79, 0x7f807f80
    s_lshl_b32 s12, s4, 16
    s_lshl_b32 s13, s5, 16
    s_lshl_b32 s14, s6, 16
    s_lshl_b32 s15, s7, 16
    s_lshl_b32 s16, s8, 16
    s_lshl_b32 s17, s9, 16
    s_lshl_b32 s18, s10, 16
    s_lshl_b32 s19, s11, 16
    s_max_u32 s4, s4, s12
    s_max_u32 s5, s5, s13
    s_max_u32 s6, s6, s14
    s_max_u32 s7, s7, s15
    s_max_u32 s8, s8, s16
    s_max_u32 s9, s9, s17
    s_max_u32 s10, s10, s18
    s_max_u32 s11, s11, s19
    s_max_u32 s4, s4, s8
    s_max_u32 s5, s5, s9
    s_max_u32 s6, s6, s10
    s_max_u32 s7, s7, s11
    s_max_u32 s4, s4, s6
    s_max_u32 s5, s5, s7
    s_max_u32 s4, s4, s5
    s_and_b32 s4, s4, 0x7f800000
    s_max_u32 s4, s4, 0xc800000
    s_min_u32 s4, s4, 0x7e800000
    s_sub_u32 s5, 0x7f000000, s4
    s_lshr_b32 s56, s4, 16
    s_sub_u32 s56, s56, 0xc00
    s_mov_b32 s6, 0x7fffffff
    s_mov_b32 s7, 0x31800000
    s_mov_b32 s8, 0xc1c00000
    v_lshlrev_b64 v[12:13], v123, s[56:57]
    s_waitcnt vmcnt(2)
    v_add_f32 v98, v98, v100
    v_sub_f32 v99, v99, v100
    v_mul_f32 v98, s37, v98
    v_mul_f32 v99, s37, v99
    s_waitcnt vmcnt(1)
    v_mul_f32 v101, s37, v101
    ds_write_b32 v120, v98
    v_cvt_pk_bf16_f32 v117, v99, v99
    ds_write_b32 v120, v101 offset:1024
    ds_write_b32 v120, v117 offset:2048
    s_cmp_lg_u32 s42, 0
    s_cbranch_scc1 L_np2
    v_mul_f32 v103, s5, v103
    v_mul_f32 v102, s37, v102
    v_max_f32_e64 v82, |v103|, s7
    v_bfi_b32 v82, s6, v82, v103
    v_rcp_f32 v86, v82
    v_add_f32 v102, s8, v102
    v_mul_f32 v87, 0x33800000, v86
    s_mov_b64 exec, 0xffff
    ds_write_b32 v118, v102 offset:3072
    ds_write_b64 v116, v[86:87] offset:3136
    ds_write_b32 v118, v105 offset:3264
    s_mov_b64 exec, -1
L_np2:
    s_waitcnt vmcnt(0)
    ds_write_b32 v123, v104 offset:7680
    s_mov_b32 exec_hi, 0x3ffff
    ds_read_u16_d16_hi v106, v15 offset:6400
    ds_read_u16_d16_hi v107, v15 offset:6500
    ds_read_u16_d16_hi v108, v15 offset:6600
    ds_read_u16_d16_hi v109, v15 offset:6700
    s_mov_b32 exec_hi, -1
    s_waitcnt lgkmcnt(0)
    s_barrier
    ds_read_b128 v[66:69], v122 offset:7680
    ds_read_b128 v[70:73], v122 offset:7744
    ds_read_b128 v[50:53], v1
    ds_read_b128 v[54:57], v1 offset:1024
    ds_read_b128 v[74:77], v122 offset:7808
    ds_read_b128 v[78:81], v122 offset:7872
    ds_read_b128 v[58:61], v1 offset:2048
    ds_read_b128 v[62:65], v121 offset:3072
    ds_read_b128 v[8:11], v121 offset:3136
    ds_read_b32 v14, v121 offset:3264
    v_cmp_lt_u32 s[48:49], s39, v106
    v_cmp_lt_u32 s[50:51], s39, v107
    v_cmp_lt_u32 s[52:53], s39, v108
    v_cmp_lt_u32 s[54:55], s39, v109
    v_or_b32 v106, v124, v106
    v_or_b32 v107, v124, v107
    v_or_b32 v108, v124, v108
    v_or_b32 v109, v124, v109
    v_cndmask_b32 v98, v125, 0, s[48:49]
    v_cndmask_b32 v99, v125, 0, s[50:51]
    v_cndmask_b32 v100, v125, 0, s[52:53]
    v_cndmask_b32 v101, v125, 0, s[54:55]
    v_mbcnt_lo_u32_b32 v98, s48, v98
    v_mbcnt_lo_u32_b32 v99, s50, v99
    v_mbcnt_lo_u32_b32 v100, s52, v100
    v_mbcnt_lo_u32_b32 v101, s54, v101
    v_mbcnt_hi_u32_b32 v98, s49, v98
    v_mbcnt_hi_u32_b32 v99, s51, v99
    v_mbcnt_hi_u32_b32 v100, s53, v100
    v_mbcnt_hi_u32_b32 v101, s55, v101
    v_lshl_add_u64 v[98:99], v[98:99], 2, s[40:41]
    v_lshl_add_u64 v[100:101], v[100:101], 2, s[40:41]
    ds_write_b32 v98, v106
    ds_write_b32 v99, v107 offset:256
    ds_write_b32 v100, v108 offset:512
    ds_write_b32 v101, v109 offset:768
    s_bcnt1_i32_b64 s56, s[48:49]
    s_bcnt1_i32_b64 s57, s[50:51]
    s_bcnt1_i32_b64 s58, s[52:53]
    s_bcnt1_i32_b64 s59, s[54:55]
    s_max_u32 s43, s56, s57
    s_max_u32 s48, s58, s59
    s_max_u32 s43, s43, s48
    ds_read2st64_b32 v[106:107], v5 offset0:0 offset1:1
    ds_read2st64_b32 v[108:109], v5 offset0:2 offset1:3
    s_waitcnt lgkmcnt(12)
    v_pk_fma_f32 v[82:83], v[66:67], v[54:55], v[50:51]
    v_pk_fma_f32 v[84:85], v[68:69], v[56:57], v[52:53]
    v_pk_fma_f32 v[86:87], v[70:71], v[54:55], v[50:51]
    v_pk_fma_f32 v[88:89], v[72:73], v[56:57], v[52:53]
    s_waitcnt lgkmcnt(11)
    v_pk_fma_f32 v[90:91], v[74:75], v[54:55], v[50:51]
    v_pk_fma_f32 v[92:93], v[76:77], v[56:57], v[52:53]
    s_waitcnt lgkmcnt(10)
    v_pk_fma_f32 v[94:95], v[78:79], v[54:55], v[50:51]
    v_pk_fma_f32 v[96:97], v[80:81], v[56:57], v[52:53]
    s_waitcnt lgkmcnt(1)
    v_add_u32_sdwa v106, v106, v6 dst_sel:DWORD dst_unused:UNUSED_PAD src0_sel:WORD_0 src1_sel:DWORD
    v_add_u32_sdwa v107, v107, v6 dst_sel:DWORD dst_unused:UNUSED_PAD src0_sel:WORD_0 src1_sel:DWORD
    s_waitcnt lgkmcnt(0)
    v_add_u32_sdwa v108, v108, v6 dst_sel:DWORD dst_unused:UNUSED_PAD src0_sel:WORD_0 src1_sel:DWORD
    v_add_u32_sdwa v109, v109, v6 dst_sel:DWORD dst_unused:UNUSED_PAD src0_sel:WORD_0 src1_sel:DWORD
    buffer_load_dwordx4 v106, s[20:23], s33 offen lds
    buffer_load_dwordx4 v107, s[20:23], s33 offen offset:1600 lds
    ds_read_u16_d16_hi v114, v7 offset:2
    ds_read_u16_d16_hi v115, v7 offset:514
    ds_read_b128 v[122:125], v121 offset:3200
    v_mfma_f32_16x16x32_bf16 v[26:29], v[58:61], v[66:69], v[62:65]
    v_mfma_f32_16x16x32_bf16 v[30:33], v[58:61], v[70:73], v[62:65]
    v_mfma_f32_16x16x32_bf16 v[34:37], v[58:61], v[74:77], v[62:65]
    v_mfma_f32_16x16x32_bf16 v[38:41], v[58:61], v[78:81], v[62:65]
    v_cvt_pk_bf16_f32 v18, v82, v83
    v_cvt_pk_bf16_f32 v19, v84, v85
    v_cvt_pk_bf16_f32 v20, v86, v87
    v_cvt_pk_bf16_f32 v21, v88, v89
    v_cvt_pk_bf16_f32 v22, v90, v91
    v_cvt_pk_bf16_f32 v23, v92, v93
    v_cvt_pk_bf16_f32 v24, v94, v95
    v_cvt_pk_bf16_f32 v25, v96, v97
    s_cmp_gt_u32 s43, 32
    s_cbranch_scc1 L_xd2
L_xb2:
    s_waitcnt vmcnt(1)
    ds_read_b64 v[50:51], v2
    ds_read_b64 v[52:53], v2 offset:512
    s_add_u32 m0, s36, 3200
    s_nop 0
    buffer_load_dwordx4 v108, s[20:23], s38 offen lds
    s_waitcnt lgkmcnt(1)
    v_mfma_f32_16x16x16_bf16 v[58:61], v[18:19], v[50:51], v[26:29]
    s_waitcnt lgkmcnt(0)
    v_mfma_f32_16x16x16_bf16 v[62:65], v[18:19], v[52:53], v[26:29]
    s_nop 5
    v_exp_f32_e64 v94, v58 clamp
    v_exp_f32_e64 v96, v59 clamp
    v_exp_f32_e64 v58, v60 clamp
    v_exp_f32_e64 v95, v62 clamp
    v_exp_f32_e64 v97, v63 clamp
    v_exp_f32_e64 v62, v61 clamp
    v_exp_f32_e64 v59, v64 clamp
    v_exp_f32_e64 v63, v65 clamp
    s_waitcnt vmcnt(1)
    ds_read_b64 v[54:55], v2 offset:1600
    ds_read_b64 v[56:57], v2 offset:2112
    buffer_load_dwordx4 v109, s[20:23], s38 offen offset:1600 lds
    v_pk_fma_f32 v[94:95], v[94:95], v[8:9], v[8:9] op_sel:[0,0,1] op_sel_hi:[1,0,1]
    v_pk_fma_f32 v[96:97], v[96:97], v[10:11], v[10:11] op_sel:[0,0,1] op_sel_hi:[1,0,1]
    v_pk_fma_f32 v[58:59], v[58:59], v[122:123], v[122:123] op_sel:[0,0,1] op_sel_hi:[1,0,1]
    v_pk_fma_f32 v[62:63], v[62:63], v[124:125], v[124:125] op_sel:[0,0,1] op_sel_hi:[1,0,1]
    v_pk_mul_f32 v[64:65], v[94:95], v[96:97]
    v_pk_add_f32 v[60:61], v[94:95], v[96:97]
    v_pk_mul_f32 v[94:95], v[64:65], v[58:59]
    v_pk_fma_f32 v[60:61], v[60:61], v[58:59], v[64:65]
    v_pk_mul_f32 v[96:97], v[94:95], v[62:63]
    v_rcp_f32 v96, v96
    v_rcp_f32 v97, v97
    v_pk_fma_f32 v[60:61], v[60:61], v[62:63], v[94:95]
    v_pk_mul_f32 v[90:91], v[60:61], v[96:97]
    s_waitcnt lgkmcnt(1)
    v_mfma_f32_16x16x16_bf16 v[66:69], v[20:21], v[54:55], v[30:33]
    s_waitcnt lgkmcnt(0)
    v_mfma_f32_16x16x16_bf16 v[70:73], v[20:21], v[56:57], v[30:33]
    s_nop 5
    v_exp_f32_e64 v94, v66 clamp
    v_exp_f32_e64 v96, v67 clamp
    v_exp_f32_e64 v66, v68 clamp
    v_exp_f32_e64 v95, v70 clamp
    v_exp_f32_e64 v97, v71 clamp
    v_exp_f32_e64 v70, v69 clamp
    v_exp_f32_e64 v67, v72 clamp
    v_exp_f32_e64 v71, v73 clamp
    s_waitcnt vmcnt(1)
    ds_read_b64 v[50:51], v2 offset:3200
    ds_read_b64 v[52:53], v2 offset:3712
    ds_read_b64_tr_b16 v[74:75], v4
    ds_read_b64_tr_b16 v[76:77], v4 offset:512
    ds_read_b64_tr_b16 v[78:79], v4 offset:1600
    ds_read_b64_tr_b16 v[80:81], v4 offset:2112
    v_pk_fma_f32 v[94:95], v[94:95], v[8:9], v[8:9] op_sel:[0,0,1] op_sel_hi:[1,0,1]
    v_pk_fma_f32 v[96:97], v[96:97], v[10:11], v[10:11] op_sel:[0,0,1] op_sel_hi:[1,0,1]
    v_pk_fma_f32 v[66:67], v[66:67], v[122:123], v[122:123] op_sel:[0,0,1] op_sel_hi:[1,0,1]
    v_pk_fma_f32 v[70:71], v[70:71], v[124:125], v[124:125] op_sel:[0,0,1] op_sel_hi:[1,0,1]
    v_pk_mul_f32 v[72:73], v[94:95], v[96:97]
    v_pk_add_f32 v[68:69], v[94:95], v[96:97]
    v_pk_mul_f32 v[94:95], v[72:73], v[66:67]
    v_pk_fma_f32 v[68:69], v[68:69], v[66:67], v[72:73]
    v_pk_mul_f32 v[96:97], v[94:95], v[70:71]
    v_rcp_f32 v96, v96
    v_rcp_f32 v97, v97
    v_pk_fma_f32 v[68:69], v[68:69], v[70:71], v[94:95]
    v_pk_mul_f32 v[68:69], v[68:69], v[96:97]
    v_cvt_pk_bf16_f32 v90, v90, v68
    v_cvt_pk_bf16_f32 v91, v91, v69
    s_waitcnt lgkmcnt(5)
    v_mfma_f32_16x16x16_bf16 v[58:61], v[22:23], v[50:51], v[34:37]
    s_waitcnt lgkmcnt(4)
    v_mfma_f32_16x16x16_bf16 v[62:65], v[22:23], v[52:53], v[34:37]
    v_mfma_f32_16x16x16_bf16 v[86:89], v[12:13], v[90:91], v[14:17]
    s_nop 4
    v_exp_f32_e64 v94, v58 clamp
    v_exp_f32_e64 v96, v59 clamp
    v_exp_f32_e64 v58, v60 clamp
    v_exp_f32_e64 v95, v62 clamp
    v_exp_f32_e64 v97, v63 clamp
    v_exp_f32_e64 v62, v61 clamp
    v_exp_f32_e64 v59, v64 clamp
    v_exp_f32_e64 v63, v65 clamp
    v_mul_f32 v116, v86, v114
    v_cvt_pk_bf16_f32 v116, v116, v116
    ds_write_b16 v15, v116 offset:7424
    ds_read2_b64 v[82:85], v16 offset0:0 offset1:8
    v_pk_fma_f32 v[94:95], v[94:95], v[8:9], v[8:9] op_sel:[0,0,1] op_sel_hi:[1,0,1]
    v_pk_fma_f32 v[96:97], v[96:97], v[10:11], v[10:11] op_sel:[0,0,1] op_sel_hi:[1,0,1]
    v_pk_fma_f32 v[58:59], v[58:59], v[122:123], v[122:123] op_sel:[0,0,1] op_sel_hi:[1,0,1]
    v_pk_fma_f32 v[62:63], v[62:63], v[124:125], v[124:125] op_sel:[0,0,1] op_sel_hi:[1,0,1]
    v_pk_mul_f32 v[64:65], v[94:95], v[96:97]
    v_pk_add_f32 v[60:61], v[94:95], v[96:97]
    v_pk_mul_f32 v[94:95], v[64:65], v[58:59]
    v_pk_fma_f32 v[60:61], v[60:61], v[58:59], v[64:65]
    v_pk_mul_f32 v[96:97], v[94:95], v[62:63]
    v_rcp_f32 v96, v96
    v_rcp_f32 v97, v97
    v_pk_fma_f32 v[60:61], v[60:61], v[62:63], v[94:95]
    v_pk_mul_f32 v[92:93], v[60:61], v[96:97]
    s_waitcnt lgkmcnt(0)
    v_mfma_f32_16x16x32_bf16 v[42:45], v[74:77], v[82:85], 0
    v_mfma_f32_16x16x32_bf16 v[46:49], v[78:81], v[82:85], 0
    s_waitcnt vmcnt(0)
    ds_read_b64 v[54:55], v2 offset:4800
    ds_read_b64 v[56:57], v2 offset:5312
    ds_read_b64_tr_b16 v[74:75], v4 offset:3200
    ds_read_b64_tr_b16 v[76:77], v4 offset:3712
    ds_read_b64_tr_b16 v[78:79], v4 offset:4800
    ds_read_b64_tr_b16 v[80:81], v4 offset:5312
    s_waitcnt lgkmcnt(5)
    v_mfma_f32_16x16x16_bf16 v[66:69], v[24:25], v[54:55], v[38:41]
    s_waitcnt lgkmcnt(4)
    v_mfma_f32_16x16x16_bf16 v[70:73], v[24:25], v[56:57], v[38:41]
    s_nop 5
    v_exp_f32_e64 v94, v66 clamp
    v_exp_f32_e64 v96, v67 clamp
    v_exp_f32_e64 v66, v68 clamp
    v_exp_f32_e64 v95, v70 clamp
    v_exp_f32_e64 v97, v71 clamp
    v_exp_f32_e64 v70, v69 clamp
    v_exp_f32_e64 v67, v72 clamp
    v_exp_f32_e64 v71, v73 clamp
    v_pk_fma_f32 v[94:95], v[94:95], v[8:9], v[8:9] op_sel:[0,0,1] op_sel_hi:[1,0,1]
    v_pk_fma_f32 v[96:97], v[96:97], v[10:11], v[10:11] op_sel:[0,0,1] op_sel_hi:[1,0,1]
    v_pk_fma_f32 v[66:67], v[66:67], v[122:123], v[122:123] op_sel:[0,0,1] op_sel_hi:[1,0,1]
    v_pk_fma_f32 v[70:71], v[70:71], v[124:125], v[124:125] op_sel:[0,0,1] op_sel_hi:[1,0,1]
    v_pk_mul_f32 v[72:73], v[94:95], v[96:97]
    v_pk_add_f32 v[68:69], v[94:95], v[96:97]
    v_pk_mul_f32 v[94:95], v[72:73], v[66:67]
    v_pk_fma_f32 v[68:69], v[68:69], v[66:67], v[72:73]
    v_pk_mul_f32 v[96:97], v[94:95], v[70:71]
    v_rcp_f32 v96, v96
    v_rcp_f32 v97, v97
    v_pk_fma_f32 v[68:69], v[68:69], v[70:71], v[94:95]
    v_pk_mul_f32 v[68:69], v[68:69], v[96:97]
    v_cvt_pk_bf16_f32 v92, v92, v68
    v_cvt_pk_bf16_f32 v93, v93, v69
    s_nop 1
    v_mfma_f32_16x16x16_bf16 v[86:89], v[12:13], v[92:93], v[14:17]
    s_nop 7
    v_mul_f32 v116, v86, v115
    v_cvt_pk_bf16_f32 v116, v116, v116
    ds_write_b16 v15, v116 offset:7552
    ds_read2_b64 v[82:85], v16 offset0:16 offset1:24
    s_waitcnt lgkmcnt(0)
    v_mfma_f32_16x16x32_bf16 v[102:105], v[74:77], v[82:85], 0
    v_mfma_f32_16x16x32_bf16 v[110:113], v[78:81], v[82:85], 0
    s_cmp_gt_u32 s43, 32
    s_cbranch_scc1 L_slowG
L_back:
    s_nop 1
    s_mov_b32 exec_lo, 0x10001
    s_mov_b32 exec_hi, 0x10001
    v_cvt_pk_bf16_f32 v118, v42, v43
    v_cvt_pk_bf16_f32 v119, v44, v45
    s_mov_b32 exec_lo, 0x20002
    s_mov_b32 exec_hi, 0x20002
    v_cvt_pk_bf16_f32 v118, v46, v47
    v_cvt_pk_bf16_f32 v119, v48, v49
    s_mov_b32 exec_lo, 0x40004
    s_mov_b32 exec_hi, 0x40004
    v_cvt_pk_bf16_f32 v118, v102, v103
    v_cvt_pk_bf16_f32 v119, v104, v105
    s_mov_b32 exec_lo, 0x80008
    s_mov_b32 exec_hi, 0x80008
    v_cvt_pk_bf16_f32 v118, v110, v111
    v_cvt_pk_bf16_f32 v119, v112, v113
    s_mov_b32 exec_lo, 0x000f000f
    s_mov_b32 exec_hi, 0x000f000f
    buffer_store_dwordx2 v[118:119], v17, s[28:31], s35 offen
L_done:
    s_endpgm
L_xd1:
    s_waitcnt lgkmcnt(0)
    s_cmp_le_u32 s56, 32
    s_cbranch_scc1 L_xs1_0
    ds_read_b32 v98, v5 offset:128
    s_add_u32 m0, s36, 1024
    s_add_u32 s48, s33, 0
    s_waitcnt lgkmcnt(0)
    v_add_u32_sdwa v98, v98, v6 dst_sel:DWORD dst_unused:UNUSED_PAD src0_sel:WORD_0 src1_sel:DWORD
    s_mov_b32 exec_hi, 15
    buffer_load_dwordx4 v98, s[20:23], s48 offen lds
    s_mov_b32 exec_hi, -1
L_xs1_0:
    s_cmp_le_u32 s57, 32
    s_cbranch_scc1 L_xs1_1
    ds_read_b32 v99, v5 offset:384
    s_add_u32 m0, s36, 2624
    s_add_u32 s48, s33, 1600
    s_waitcnt lgkmcnt(0)
    v_add_u32_sdwa v99, v99, v6 dst_sel:DWORD dst_unused:UNUSED_PAD src0_sel:WORD_0 src1_sel:DWORD
    s_mov_b32 exec_hi, 15
    buffer_load_dwordx4 v99, s[20:23], s48 offen lds
    s_mov_b32 exec_hi, -1
L_xs1_1:
    s_cmp_le_u32 s58, 32
    s_cbranch_scc1 L_xs1_2
    ds_read_b32 v100, v5 offset:640
    s_add_u32 m0, s36, 4224
    s_add_u32 s48, s33, 3200
    s_waitcnt lgkmcnt(0)
    v_add_u32_sdwa v100, v100, v6 dst_sel:DWORD dst_unused:UNUSED_PAD src0_sel:WORD_0 src1_sel:DWORD
    s_mov_b32 exec_hi, 15
    buffer_load_dwordx4 v100, s[20:23], s48 offen lds
    s_mov_b32 exec_hi, -1
L_xs1_2:
    s_cmp_le_u32 s59, 32
    s_cbranch_scc1 L_xs1_3
    ds_read_b32 v101, v5 offset:896
    s_add_u32 m0, s36, 5824
    s_add_u32 s48, s33, 4800
    s_waitcnt lgkmcnt(0)
    v_add_u32_sdwa v101, v101, v6 dst_sel:DWORD dst_unused:UNUSED_PAD src0_sel:WORD_0 src1_sel:DWORD
    s_mov_b32 exec_hi, 15
    buffer_load_dwordx4 v101, s[20:23], s48 offen lds
    s_mov_b32 exec_hi, -1
L_xs1_3:
    s_add_u32 m0, s36, 3200
    s_branch L_xb1
L_xd2:
    s_waitcnt lgkmcnt(0)
    s_cmp_le_u32 s56, 32
    s_cbranch_scc1 L_xs2_0
    ds_read_b32 v98, v5 offset:128
    s_add_u32 m0, s36, 1024
    s_add_u32 s48, s33, 0
    s_waitcnt lgkmcnt(0)
    v_add_u32_sdwa v98, v98, v6 dst_sel:DWORD dst_unused:UNUSED_PAD src0_sel:WORD_0 src1_sel:DWORD
    s_mov_b32 exec_hi, 15
    buffer_load_dwordx4 v98, s[20:23], s48 offen lds
    s_mov_b32 exec_hi, -1
L_xs2_0:
    s_cmp_le_u32 s57, 32
    s_cbranch_scc1 L_xs2_1
    ds_read_b32 v99, v5 offset:384
    s_add_u32 m0, s36, 2624
    s_add_u32 s48, s33, 1600
    s_waitcnt lgkmcnt(0)
    v_add_u32_sdwa v99, v99, v6 dst_sel:DWORD dst_unused:UNUSED_PAD src0_sel:WORD_0 src1_sel:DWORD
    s_mov_b32 exec_hi, 15
    buffer_load_dwordx4 v99, s[20:23], s48 offen lds
    s_mov_b32 exec_hi, -1
L_xs2_1:
    s_cmp_le_u32 s58, 32
    s_cbranch_scc1 L_xs2_2
    ds_read_b32 v100, v5 offset:640
    s_add_u32 m0, s36, 4224
    s_add_u32 s48, s33, 3200
    s_waitcnt lgkmcnt(0)
    v_add_u32_sdwa v100, v100, v6 dst_sel:DWORD dst_unused:UNUSED_PAD src0_sel:WORD_0 src1_sel:DWORD
    s_mov_b32 exec_hi, 15
    buffer_load_dwordx4 v100, s[20:23], s48 offen lds
    s_mov_b32 exec_hi, -1
L_xs2_2:
    s_cmp_le_u32 s59, 32
    s_cbranch_scc1 L_xs2_3
    ds_read_b32 v101, v5 offset:896
    s_add_u32 m0, s36, 5824
    s_add_u32 s48, s33, 4800
    s_waitcnt lgkmcnt(0)
    v_add_u32_sdwa v101, v101, v6 dst_sel:DWORD dst_unused:UNUSED_PAD src0_sel:WORD_0 src1_sel:DWORD
    s_mov_b32 exec_hi, 15
    buffer_load_dwordx4 v101, s[20:23], s48 offen lds
    s_mov_b32 exec_hi, -1
L_xs2_3:
    s_add_u32 m0, s36, 0
    s_branch L_xb2
L_slowG:
    s_nop 3
    s_cmp_le_u32 s56, 32
    s_cbranch_scc1 L_skG0
    ds_read_u16_d16_hi v114, v7 offset:130
    ds_read_b64 v[50:51], v2 offset:1024
    ds_read_b64 v[52:53], v2 offset:1536
    ds_read_b64_tr_b16 v[74:75], v4 offset:1024
    ds_read_b64_tr_b16 v[76:77], v4 offset:1536
    s_waitcnt lgkmcnt(3)
    v_mfma_f32_16x16x16_bf16 v[58:61], v[18:19], v[50:51], v[26:29]
    s_waitcnt lgkmcnt(2)
    v_mfma_f32_16x16x16_bf16 v[62:65], v[18:19], v[52:53], v[26:29]
    s_nop 5
    v_exp_f32_e64 v94, v58 clamp
    v_exp_f32_e64 v96, v59 clamp
    v_exp_f32_e64 v58, v60 clamp
    v_exp_f32_e64 v95, v62 clamp
    v_exp_f32_e64 v97, v63 clamp
    v_exp_f32_e64 v62, v61 clamp
    v_exp_f32_e64 v59, v64 clamp
    v_exp_f32_e64 v63, v65 clamp
    v_pk_fma_f32 v[94:95], v[94:95], v[8:9], v[8:9] op_sel:[0,0,1] op_sel_hi:[1,0,1]
    v_pk_fma_f32 v[96:97], v[96:97], v[10:11], v[10:11] op_sel:[0,0,1] op_sel_hi:[1,0,1]
    v_pk_fma_f32 v[58:59], v[58:59], v[122:123], v[122:123] op_sel:[0,0,1] op_sel_hi:[1,0,1]
    v_pk_fma_f32 v[62:63], v[62:63], v[124:125], v[124:125] op_sel:[0,0,1] op_sel_hi:[1,0,1]
    v_pk_mul_f32 v[64:65], v[94:95], v[96:97]
    v_pk_add_f32 v[60:61], v[94:95], v[96:97]
    v_pk_mul_f32 v[94:95], v[64:65], v[58:59]
    v_pk_fma_f32 v[60:61], v[60:61], v[58:59], v[64:65]
    v_pk_mul_f32 v[96:97], v[94:95], v[62:63]
    v_rcp_f32 v96, v96
    v_rcp_f32 v97, v97
    v_pk_fma_f32 v[60:61], v[60:61], v[62:63], v[94:95]
    v_pk_mul_f32 v[60:61], v[60:61], v[96:97]
    v_cvt_pk_bf16_f32 v90, v60, v60
    v_cvt_pk_bf16_f32 v91, v61, v61
    s_nop 1
    v_mfma_f32_16x16x16_bf16 v[86:89], v[12:13], v[90:91], v[14:17]
    s_nop 7
    v_mul_f32 v116, v86, v114
    v_cvt_pk_bf16_f32 v116, v116, v116
    s_mov_b32 exec_lo, 0xffff
    s_mov_b32 exec_hi, 0xffff
    ds_write_b16 v15, v116 offset:7424
    s_mov_b64 exec, -1
    ds_read2_b64 v[82:85], v16 offset0:0 offset1:8
    s_waitcnt lgkmcnt(0)
    v_mfma_f32_16x16x32_bf16 v[42:45], v[74:77], v[82:85], v[42:45]
    s_nop 9
L_skG0:
    s_cmp_le_u32 s57, 32
    s_cbranch_scc1 L_skG1
    ds_read_u16_d16_hi v114, v7 offset:386
    ds_read_b64 v[50:51], v2 offset:2624
    ds_read_b64 v[52:53], v2 offset:3136
    ds_read_b64_tr_b16 v[74:75], v4 offset:2624
    ds_read_b64_tr_b16 v[76:77], v4 offset:3136
    s_waitcnt lgkmcnt(3)
    v_mfma_f32_16x16x16_bf16 v[58:61], v[20:21], v[50:51], v[30:33]
    s_waitcnt lgkmcnt(2)
    v_mfma_f32_16x16x16_bf16 v[62:65], v[20:21], v[52:53], v[30:33]
    s_nop 5
    v_exp_f32_e64 v94, v58 clamp
    v_exp_f32_e64 v96, v59 clamp
    v_exp_f32_e64 v58, v60 clamp
    v_exp_f32_e64 v95, v62 clamp
    v_exp_f32_e64 v97, v63 clamp
    v_exp_f32_e64 v62, v61 clamp
    v_exp_f32_e64 v59, v64 clamp
    v_exp_f32_e64 v63, v65 clamp
    v_pk_fma_f32 v[94:95], v[94:95], v[8:9], v[8:9] op_sel:[0,0,1] op_sel_hi:[1,0,1]
    v_pk_fma_f32 v[96:97], v[96:97], v[10:11], v[10:11] op_sel:[0,0,1] op_sel_hi:[1,0,1]
    v_pk_fma_f32 v[58:59], v[58:59], v[122:123], v[122:123] op_sel:[0,0,1] op_sel_hi:[1,0,1]
    v_pk_fma_f32 v[62:63], v[62:63], v[124:125], v[124:125] op_sel:[0,0,1] op_sel_hi:[1,0,1]
    v_pk_mul_f32 v[64:65], v[94:95], v[96:97]
    v_pk_add_f32 v[60:61], v[94:95], v[96:97]
    v_pk_mul_f32 v[94:95], v[64:65], v[58:59]
    v_pk_fma_f32 v[60:61], v[60:61], v[58:59], v[64:65]
    v_pk_mul_f32 v[96:97], v[94:95], v[62:63]
    v_rcp_f32 v96, v96
    v_rcp_f32 v97, v97
    v_pk_fma_f32 v[60:61], v[60:61], v[62:63], v[94:95]
    v_pk_mul_f32 v[60:61], v[60:61], v[96:97]
    v_cvt_pk_bf16_f32 v90, v60, v60
    v_cvt_pk_bf16_f32 v91, v61, v61
    s_nop 1
    v_mfma_f32_16x16x16_bf16 v[86:89], v[12:13], v[90:91], v[14:17]
    s_nop 7
    v_mul_f32 v116, v86, v114
    v_cvt_pk_bf16_f32 v116, v116, v116
    s_mov_b32 exec_lo, 0xffff
    s_mov_b32 exec_hi, 0xffff
    ds_write_b16 v15, v116 offset:7456
    s_mov_b64 exec, -1
    ds_read2_b64 v[82:85], v16 offset0:0 offset1:8
    s_waitcnt lgkmcnt(0)
    v_mfma_f32_16x16x32_bf16 v[46:49], v[74:77], v[82:85], v[46:49]
    s_nop 9
L_skG1:
    s_cmp_le_u32 s58, 32
    s_cbranch_scc1 L_skG2
    ds_read_u16_d16_hi v114, v7 offset:642
    ds_read_b64 v[50:51], v2 offset:4224
    ds_read_b64 v[52:53], v2 offset:4736
    ds_read_b64_tr_b16 v[74:75], v4 offset:4224
    ds_read_b64_tr_b16 v[76:77], v4 offset:4736
    s_waitcnt lgkmcnt(3)
    v_mfma_f32_16x16x16_bf16 v[58:61], v[22:23], v[50:51], v[34:37]
    s_waitcnt lgkmcnt(2)
    v_mfma_f32_16x16x16_bf16 v[62:65], v[22:23], v[52:53], v[34:37]
    s_nop 5
    v_exp_f32_e64 v94, v58 clamp
    v_exp_f32_e64 v96, v59 clamp
    v_exp_f32_e64 v58, v60 clamp
    v_exp_f32_e64 v95, v62 clamp
    v_exp_f32_e64 v97, v63 clamp
    v_exp_f32_e64 v62, v61 clamp
    v_exp_f32_e64 v59, v64 clamp
    v_exp_f32_e64 v63, v65 clamp
    v_pk_fma_f32 v[94:95], v[94:95], v[8:9], v[8:9] op_sel:[0,0,1] op_sel_hi:[1,0,1]
    v_pk_fma_f32 v[96:97], v[96:97], v[10:11], v[10:11] op_sel:[0,0,1] op_sel_hi:[1,0,1]
    v_pk_fma_f32 v[58:59], v[58:59], v[122:123], v[122:123] op_sel:[0,0,1] op_sel_hi:[1,0,1]
    v_pk_fma_f32 v[62:63], v[62:63], v[124:125], v[124:125] op_sel:[0,0,1] op_sel_hi:[1,0,1]
    v_pk_mul_f32 v[64:65], v[94:95], v[96:97]
    v_pk_add_f32 v[60:61], v[94:95], v[96:97]
    v_pk_mul_f32 v[94:95], v[64:65], v[58:59]
    v_pk_fma_f32 v[60:61], v[60:61], v[58:59], v[64:65]
    v_pk_mul_f32 v[96:97], v[94:95], v[62:63]
    v_rcp_f32 v96, v96
    v_rcp_f32 v97, v97
    v_pk_fma_f32 v[60:61], v[60:61], v[62:63], v[94:95]
    v_pk_mul_f32 v[60:61], v[60:61], v[96:97]
    v_cvt_pk_bf16_f32 v90, v60, v60
    v_cvt_pk_bf16_f32 v91, v61, v61
    s_nop 1
    v_mfma_f32_16x16x16_bf16 v[86:89], v[12:13], v[90:91], v[14:17]
    s_nop 7
    v_mul_f32 v116, v86, v114
    v_cvt_pk_bf16_f32 v116, v116, v116
    s_mov_b32 exec_lo, 0xffff
    s_mov_b32 exec_hi, 0xffff
    ds_write_b16 v15, v116 offset:7552
    s_mov_b64 exec, -1
    ds_read2_b64 v[82:85], v16 offset0:16 offset1:24
    s_waitcnt lgkmcnt(0)
    v_mfma_f32_16x16x32_bf16 v[102:105], v[74:77], v[82:85], v[102:105]
    s_nop 9
L_skG2:
    s_cmp_le_u32 s59, 32
    s_cbranch_scc1 L_skG3
    ds_read_u16_d16_hi v114, v7 offset:898
    ds_read_b64 v[50:51], v2 offset:5824
    ds_read_b64 v[52:53], v2 offset:6336
    ds_read_b64_tr_b16 v[74:75], v4 offset:5824
    ds_read_b64_tr_b16 v[76:77], v4 offset:6336
    s_waitcnt lgkmcnt(3)
    v_mfma_f32_16x16x16_bf16 v[58:61], v[24:25], v[50:51], v[38:41]
    s_waitcnt lgkmcnt(2)
    v_mfma_f32_16x16x16_bf16 v[62:65], v[24:25], v[52:53], v[38:41]
    s_nop 5
    v_exp_f32_e64 v94, v58 clamp
    v_exp_f32_e64 v96, v59 clamp
    v_exp_f32_e64 v58, v60 clamp
    v_exp_f32_e64 v95, v62 clamp
    v_exp_f32_e64 v97, v63 clamp
    v_exp_f32_e64 v62, v61 clamp
    v_exp_f32_e64 v59, v64 clamp
    v_exp_f32_e64 v63, v65 clamp
    v_pk_fma_f32 v[94:95], v[94:95], v[8:9], v[8:9] op_sel:[0,0,1] op_sel_hi:[1,0,1]
    v_pk_fma_f32 v[96:97], v[96:97], v[10:11], v[10:11] op_sel:[0,0,1] op_sel_hi:[1,0,1]
    v_pk_fma_f32 v[58:59], v[58:59], v[122:123], v[122:123] op_sel:[0,0,1] op_sel_hi:[1,0,1]
    v_pk_fma_f32 v[62:63], v[62:63], v[124:125], v[124:125] op_sel:[0,0,1] op_sel_hi:[1,0,1]
    v_pk_mul_f32 v[64:65], v[94:95], v[96:97]
    v_pk_add_f32 v[60:61], v[94:95], v[96:97]
    v_pk_mul_f32 v[94:95], v[64:65], v[58:59]
    v_pk_fma_f32 v[60:61], v[60:61], v[58:59], v[64:65]
    v_pk_mul_f32 v[96:97], v[94:95], v[62:63]
    v_rcp_f32 v96, v96
    v_rcp_f32 v97, v97
    v_pk_fma_f32 v[60:61], v[60:61], v[62:63], v[94:95]
    v_pk_mul_f32 v[60:61], v[60:61], v[96:97]
    v_cvt_pk_bf16_f32 v90, v60, v60
    v_cvt_pk_bf16_f32 v91, v61, v61
    s_nop 1
    v_mfma_f32_16x16x16_bf16 v[86:89], v[12:13], v[90:91], v[14:17]
    s_nop 7
    v_mul_f32 v116, v86, v114
    v_cvt_pk_bf16_f32 v116, v116, v116
    s_mov_b32 exec_lo, 0xffff
    s_mov_b32 exec_hi, 0xffff
    ds_write_b16 v15, v116 offset:7584
    s_mov_b64 exec, -1
    ds_read2_b64 v[82:85], v16 offset0:16 offset1:24
    s_waitcnt lgkmcnt(0)
    v_mfma_f32_16x16x32_bf16 v[110:113], v[74:77], v[82:85], v[110:113]
    s_nop 9
L_skG3:
    s_branch L_back
L_slowL:
    s_nop 3
    s_cmp_le_u32 s56, 32
    s_cbranch_scc1 L_skL0
    ds_read_b64 v[98:99], v5 offset:128
    ds_read_b64 v[106:107], v6 offset:128
    ds_read_u16_d16_hi v114, v7 offset:130
    s_waitcnt lgkmcnt(2)
    v_add_u32_sdwa v98, v98, v2 dst_sel:DWORD dst_unused:UNUSED_PAD src0_sel:WORD_0 src1_sel:DWORD
    v_add_u32_sdwa v99, v99, v2 dst_sel:DWORD dst_unused:UNUSED_PAD src0_sel:WORD_0 src1_sel:DWORD
    ds_read_b64 v[50:51], v98
    ds_read_b64 v[52:53], v99
    s_waitcnt lgkmcnt(3)
    v_add_u32_sdwa v106, v106, v4 dst_sel:DWORD dst_unused:UNUSED_PAD src0_sel:WORD_0 src1_sel:DWORD
    v_add_u32_sdwa v107, v107, v4 dst_sel:DWORD dst_unused:UNUSED_PAD src0_sel:WORD_0 src1_sel:DWORD
    ds_read_b64_tr_b16 v[74:75], v106
    ds_read_b64_tr_b16 v[76:77], v107
    s_waitcnt lgkmcnt(3)
    v_mfma_f32_16x16x16_bf16 v[58:61], v[18:19], v[50:51], v[26:29]
    s_waitcnt lgkmcnt(2)
    v_mfma_f32_16x16x16_bf16 v[62:65], v[18:19], v[52:53], v[26:29]
    s_nop 5
    v_exp_f32_e64 v94, v58 clamp
    v_exp_f32_e64 v96, v59 clamp
    v_exp_f32_e64 v58, v60 clamp
    v_exp_f32_e64 v95, v62 clamp
    v_exp_f32_e64 v97, v63 clamp
    v_exp_f32_e64 v62, v61 clamp
    v_exp_f32_e64 v59, v64 clamp
    v_exp_f32_e64 v63, v65 clamp
    v_pk_fma_f32 v[94:95], v[94:95], v[8:9], v[8:9] op_sel:[0,0,1] op_sel_hi:[1,0,1]
    v_pk_fma_f32 v[96:97], v[96:97], v[10:11], v[10:11] op_sel:[0,0,1] op_sel_hi:[1,0,1]
    v_pk_fma_f32 v[58:59], v[58:59], v[122:123], v[122:123] op_sel:[0,0,1] op_sel_hi:[1,0,1]
    v_pk_fma_f32 v[62:63], v[62:63], v[124:125], v[124:125] op_sel:[0,0,1] op_sel_hi:[1,0,1]
    v_pk_mul_f32 v[64:65], v[94:95], v[96:97]
    v_pk_add_f32 v[60:61], v[94:95], v[96:97]
    v_pk_mul_f32 v[94:95], v[64:65], v[58:59]
    v_pk_fma_f32 v[60:61], v[60:61], v[58:59], v[64:65]
    v_pk_mul_f32 v[96:97], v[94:95], v[62:63]
    v_rcp_f32 v96, v96
    v_rcp_f32 v97, v97
    v_pk_fma_f32 v[60:61], v[60:61], v[62:63], v[94:95]
    v_pk_mul_f32 v[60:61], v[60:61], v[96:97]
    v_cvt_pk_bf16_f32 v90, v60, v60
    v_cvt_pk_bf16_f32 v91, v61, v61
    s_nop 1
    v_mfma_f32_16x16x16_bf16 v[86:89], v[12:13], v[90:91], v[14:17]
    s_nop 7
    v_mul_f32 v116, v86, v114
    v_cvt_pk_bf16_f32 v116, v116, v116
    s_mov_b32 exec_lo, 0xffff
    s_mov_b32 exec_hi, 0xffff
    ds_write_b16 v15, v116 offset:7424
    s_mov_b64 exec, -1
    ds_read2_b64 v[82:85], v16 offset0:0 offset1:8
    s_waitcnt lgkmcnt(0)
    v_mfma_f32_16x16x32_bf16 v[42:45], v[74:77], v[82:85], v[42:45]
    s_nop 9
L_skL0:
    s_cmp_le_u32 s57, 32
    s_cbranch_scc1 L_skL1
    ds_read_b64 v[98:99], v5 offset:384
    ds_read_b64 v[106:107], v6 offset:384
    ds_read_u16_d16_hi v114, v7 offset:386
    s_waitcnt lgkmcnt(2)
    v_add_u32_sdwa v98, v98, v2 dst_sel:DWORD dst_unused:UNUSED_PAD src0_sel:WORD_0 src1_sel:DWORD
    v_add_u32_sdwa v99, v99, v2 dst_sel:DWORD dst_unused:UNUSED_PAD src0_sel:WORD_0 src1_sel:DWORD
    ds_read_b64 v[50:51], v98 offset:1600
    ds_read_b64 v[52:53], v99 offset:1600
    s_waitcnt lgkmcnt(3)
    v_add_u32_sdwa v106, v106, v4 dst_sel:DWORD dst_unused:UNUSED_PAD src0_sel:WORD_0 src1_sel:DWORD
    v_add_u32_sdwa v107, v107, v4 dst_sel:DWORD dst_unused:UNUSED_PAD src0_sel:WORD_0 src1_sel:DWORD
    ds_read_b64_tr_b16 v[74:75], v106 offset:1600
    ds_read_b64_tr_b16 v[76:77], v107 offset:1600
    s_waitcnt lgkmcnt(3)
    v_mfma_f32_16x16x16_bf16 v[58:61], v[20:21], v[50:51], v[30:33]
    s_waitcnt lgkmcnt(2)
    v_mfma_f32_16x16x16_bf16 v[62:65], v[20:21], v[52:53], v[30:33]
    s_nop 5
    v_exp_f32_e64 v94, v58 clamp
    v_exp_f32_e64 v96, v59 clamp
    v_exp_f32_e64 v58, v60 clamp
    v_exp_f32_e64 v95, v62 clamp
    v_exp_f32_e64 v97, v63 clamp
    v_exp_f32_e64 v62, v61 clamp
    v_exp_f32_e64 v59, v64 clamp
    v_exp_f32_e64 v63, v65 clamp
    v_pk_fma_f32 v[94:95], v[94:95], v[8:9], v[8:9] op_sel:[0,0,1] op_sel_hi:[1,0,1]
    v_pk_fma_f32 v[96:97], v[96:97], v[10:11], v[10:11] op_sel:[0,0,1] op_sel_hi:[1,0,1]
    v_pk_fma_f32 v[58:59], v[58:59], v[122:123], v[122:123] op_sel:[0,0,1] op_sel_hi:[1,0,1]
    v_pk_fma_f32 v[62:63], v[62:63], v[124:125], v[124:125] op_sel:[0,0,1] op_sel_hi:[1,0,1]
    v_pk_mul_f32 v[64:65], v[94:95], v[96:97]
    v_pk_add_f32 v[60:61], v[94:95], v[96:97]
    v_pk_mul_f32 v[94:95], v[64:65], v[58:59]
    v_pk_fma_f32 v[60:61], v[60:61], v[58:59], v[64:65]
    v_pk_mul_f32 v[96:97], v[94:95], v[62:63]
    v_rcp_f32 v96, v96
    v_rcp_f32 v97, v97
    v_pk_fma_f32 v[60:61], v[60:61], v[62:63], v[94:95]
    v_pk_mul_f32 v[60:61], v[60:61], v[96:97]
    v_cvt_pk_bf16_f32 v90, v60, v60
    v_cvt_pk_bf16_f32 v91, v61, v61
    s_nop 1
    v_mfma_f32_16x16x16_bf16 v[86:89], v[12:13], v[90:91], v[14:17]
    s_nop 7
    v_mul_f32 v116, v86, v114
    v_cvt_pk_bf16_f32 v116, v116, v116
    s_mov_b32 exec_lo, 0xffff
    s_mov_b32 exec_hi, 0xffff
    ds_write_b16 v15, v116 offset:7456
    s_mov_b64 exec, -1
    ds_read2_b64 v[82:85], v16 offset0:0 offset1:8
    s_waitcnt lgkmcnt(0)
    v_mfma_f32_16x16x32_bf16 v[46:49], v[74:77], v[82:85], v[46:49]
    s_nop 9
L_skL1:
    s_cmp_le_u32 s58, 32
    s_cbranch_scc1 L_skL2
    ds_read_b64 v[98:99], v5 offset:640
    ds_read_b64 v[106:107], v6 offset:640
    ds_read_u16_d16_hi v114, v7 offset:642
    s_waitcnt lgkmcnt(2)
    v_add_u32_sdwa v98, v98, v2 dst_sel:DWORD dst_unused:UNUSED_PAD src0_sel:WORD_0 src1_sel:DWORD
    v_add_u32_sdwa v99, v99, v2 dst_sel:DWORD dst_unused:UNUSED_PAD src0_sel:WORD_0 src1_sel:DWORD
    ds_read_b64 v[50:51], v98 offset:3200
    ds_read_b64 v[52:53], v99 offset:3200
    s_waitcnt lgkmcnt(3)
    v_add_u32_sdwa v106, v106, v4 dst_sel:DWORD dst_unused:UNUSED_PAD src0_sel:WORD_0 src1_sel:DWORD
    v_add_u32_sdwa v107, v107, v4 dst_sel:DWORD dst_unused:UNUSED_PAD src0_sel:WORD_0 src1_sel:DWORD
    ds_read_b64_tr_b16 v[74:75], v106 offset:3200
    ds_read_b64_tr_b16 v[76:77], v107 offset:3200
    s_waitcnt lgkmcnt(3)
    v_mfma_f32_16x16x16_bf16 v[58:61], v[22:23], v[50:51], v[34:37]
    s_waitcnt lgkmcnt(2)
    v_mfma_f32_16x16x16_bf16 v[62:65], v[22:23], v[52:53], v[34:37]
    s_nop 5
    v_exp_f32_e64 v94, v58 clamp
    v_exp_f32_e64 v96, v59 clamp
    v_exp_f32_e64 v58, v60 clamp
    v_exp_f32_e64 v95, v62 clamp
    v_exp_f32_e64 v97, v63 clamp
    v_exp_f32_e64 v62, v61 clamp
    v_exp_f32_e64 v59, v64 clamp
    v_exp_f32_e64 v63, v65 clamp
    v_pk_fma_f32 v[94:95], v[94:95], v[8:9], v[8:9] op_sel:[0,0,1] op_sel_hi:[1,0,1]
    v_pk_fma_f32 v[96:97], v[96:97], v[10:11], v[10:11] op_sel:[0,0,1] op_sel_hi:[1,0,1]
    v_pk_fma_f32 v[58:59], v[58:59], v[122:123], v[122:123] op_sel:[0,0,1] op_sel_hi:[1,0,1]
    v_pk_fma_f32 v[62:63], v[62:63], v[124:125], v[124:125] op_sel:[0,0,1] op_sel_hi:[1,0,1]
    v_pk_mul_f32 v[64:65], v[94:95], v[96:97]
    v_pk_add_f32 v[60:61], v[94:95], v[96:97]
    v_pk_mul_f32 v[94:95], v[64:65], v[58:59]
    v_pk_fma_f32 v[60:61], v[60:61], v[58:59], v[64:65]
    v_pk_mul_f32 v[96:97], v[94:95], v[62:63]
    v_rcp_f32 v96, v96
    v_rcp_f32 v97, v97
    v_pk_fma_f32 v[60:61], v[60:61], v[62:63], v[94:95]
    v_pk_mul_f32 v[60:61], v[60:61], v[96:97]
    v_cvt_pk_bf16_f32 v90, v60, v60
    v_cvt_pk_bf16_f32 v91, v61, v61
    s_nop 1
    v_mfma_f32_16x16x16_bf16 v[86:89], v[12:13], v[90:91], v[14:17]
    s_nop 7
    v_mul_f32 v116, v86, v114
    v_cvt_pk_bf16_f32 v116, v116, v116
    s_mov_b32 exec_lo, 0xffff
    s_mov_b32 exec_hi, 0xffff
    ds_write_b16 v15, v116 offset:7552
    s_mov_b64 exec, -1
    ds_read2_b64 v[82:85], v16 offset0:16 offset1:24
    s_waitcnt lgkmcnt(0)
    v_mfma_f32_16x16x32_bf16 v[102:105], v[74:77], v[82:85], v[102:105]
    s_nop 9
L_skL2:
    s_cmp_le_u32 s59, 32
    s_cbranch_scc1 L_skL3
    ds_read_b64 v[98:99], v5 offset:896
    ds_read_b64 v[106:107], v6 offset:896
    ds_read_u16_d16_hi v114, v7 offset:898
    s_waitcnt lgkmcnt(2)
    v_add_u32_sdwa v98, v98, v2 dst_sel:DWORD dst_unused:UNUSED_PAD src0_sel:WORD_0 src1_sel:DWORD
    v_add_u32_sdwa v99, v99, v2 dst_sel:DWORD dst_unused:UNUSED_PAD src0_sel:WORD_0 src1_sel:DWORD
    ds_read_b64 v[50:51], v98 offset:4800
    ds_read_b64 v[52:53], v99 offset:4800
    s_waitcnt lgkmcnt(3)
    v_add_u32_sdwa v106, v106, v4 dst_sel:DWORD dst_unused:UNUSED_PAD src0_sel:WORD_0 src1_sel:DWORD
    v_add_u32_sdwa v107, v107, v4 dst_sel:DWORD dst_unused:UNUSED_PAD src0_sel:WORD_0 src1_sel:DWORD
    ds_read_b64_tr_b16 v[74:75], v106 offset:4800
    ds_read_b64_tr_b16 v[76:77], v107 offset:4800
    s_waitcnt lgkmcnt(3)
    v_mfma_f32_16x16x16_bf16 v[58:61], v[24:25], v[50:51], v[38:41]
    s_waitcnt lgkmcnt(2)
    v_mfma_f32_16x16x16_bf16 v[62:65], v[24:25], v[52:53], v[38:41]
    s_nop 5
    v_exp_f32_e64 v94, v58 clamp
    v_exp_f32_e64 v96, v59 clamp
    v_exp_f32_e64 v58, v60 clamp
    v_exp_f32_e64 v95, v62 clamp
    v_exp_f32_e64 v97, v63 clamp
    v_exp_f32_e64 v62, v61 clamp
    v_exp_f32_e64 v59, v64 clamp
    v_exp_f32_e64 v63, v65 clamp
    v_pk_fma_f32 v[94:95], v[94:95], v[8:9], v[8:9] op_sel:[0,0,1] op_sel_hi:[1,0,1]
    v_pk_fma_f32 v[96:97], v[96:97], v[10:11], v[10:11] op_sel:[0,0,1] op_sel_hi:[1,0,1]
    v_pk_fma_f32 v[58:59], v[58:59], v[122:123], v[122:123] op_sel:[0,0,1] op_sel_hi:[1,0,1]
    v_pk_fma_f32 v[62:63], v[62:63], v[124:125], v[124:125] op_sel:[0,0,1] op_sel_hi:[1,0,1]
    v_pk_mul_f32 v[64:65], v[94:95], v[96:97]
    v_pk_add_f32 v[60:61], v[94:95], v[96:97]
    v_pk_mul_f32 v[94:95], v[64:65], v[58:59]
    v_pk_fma_f32 v[60:61], v[60:61], v[58:59], v[64:65]
    v_pk_mul_f32 v[96:97], v[94:95], v[62:63]
    v_rcp_f32 v96, v96
    v_rcp_f32 v97, v97
    v_pk_fma_f32 v[60:61], v[60:61], v[62:63], v[94:95]
    v_pk_mul_f32 v[60:61], v[60:61], v[96:97]
    v_cvt_pk_bf16_f32 v90, v60, v60
    v_cvt_pk_bf16_f32 v91, v61, v61
    s_nop 1
    v_mfma_f32_16x16x16_bf16 v[86:89], v[12:13], v[90:91], v[14:17]
    s_nop 7
    v_mul_f32 v116, v86, v114
    v_cvt_pk_bf16_f32 v116, v116, v116
    s_mov_b32 exec_lo, 0xffff
    s_mov_b32 exec_hi, 0xffff
    ds_write_b16 v15, v116 offset:7584
    s_mov_b64 exec, -1
    ds_read2_b64 v[82:85], v16 offset0:16 offset1:24
    s_waitcnt lgkmcnt(0)
    v_mfma_f32_16x16x32_bf16 v[110:113], v[74:77], v[82:85], v[110:113]
    s_nop 9
L_skL3:
    s_branch L_back
L_codeend:
.section .rodata,"a"
.p2align 6
.amdhsa_kernel standalone__sequential_behavior_din__recsys_kernel
  .amdhsa_next_free_vgpr 126
  .amdhsa_next_free_sgpr 80
  .amdhsa_accum_offset 128
  .amdhsa_group_segment_fixed_size 0
  .amdhsa_kernarg_size 80
  .amdhsa_user_sgpr_count 2
  .amdhsa_user_sgpr_kernarg_segment_ptr 1
  .amdhsa_system_sgpr_workgroup_id_x 1
.end_amdhsa_kernel
```
